```python
import torch

def _softmax(x, axis=-1):
    return torch.softmax(x, dim=axis)
def _gelu(x):
    return torch.nn.functional.gelu(x, approximate="tanh")
def _silu(x):
    return torch.nn.functional.silu(x)
def _sigmoid(x):
    return torch.sigmoid(x)
def _layernorm(x, axis=-1, eps=1e-5):
    m = x.mean(dim=axis, keepdim=True)
    v = x.var(dim=axis, keepdim=True, unbiased=False)
    return (x - m) / torch.sqrt(v + eps)
def _scatter_add(tgt, idx, src, axis=0):
    return tgt.clone().index_add_(axis, idx, src)
def _segment_sum(src, seg, n):
    out = torch.zeros((n,) + src.shape[1:], dtype=src.dtype)
    return out.index_add_(0, seg, src)
def _pad(x, pw):
    flat = tuple(v for pair in reversed(pw) for v in pair)
    return torch.nn.functional.pad(x, flat)

kernel_name = 'standalone__cheap_equivariant_egnn__graph'

def setup_inputs():

    _w = (lambda a: (lambda t: t.to(torch.bfloat16) if t.is_floating_point() else t)(torch.as_tensor(a)))
    N, deg, D, De = 10000, 16, 128, max(0, 1)
    E = N * deg
    return {
        "h": _w((lambda *s: torch.randn(*s, dtype=torch.bfloat16) * 0.2)(N, D)),
        "pos": _w((lambda *s: torch.randn(*s, dtype=torch.bfloat16) * 0.8)(N, 3)),
        "e_attr": _w((lambda *s: torch.randn(*s, dtype=torch.bfloat16) * 0.8)(E, De)),
        "src": _w((lambda lo, hi, *s: torch.randint(lo, hi, s))(0, N, E).to(torch.int64)),
        "dst": _w((lambda lo, hi, *s: torch.randint(lo, hi, s))(0, N, E).to(torch.int64)),
        "w_e": _w(0.1 * (lambda *s: torch.randn(*s, dtype=torch.bfloat16) * 0.8)(2 * D + 1 + De, D)),
        "w_x": _w(0.1 * (lambda *s: torch.randn(*s, dtype=torch.bfloat16) * 0.2)(D, 1)),
        "w_h": _w(0.1 * (lambda *s: torch.randn(*s, dtype=torch.bfloat16) * 0.2)(2 * D, D)),
    }

def reference(h, pos, e_attr, src, dst, w_e, w_x, w_h):
    N, D = h.shape[0], h.shape[1]
    diff = pos[dst] - pos[src]
    dist2 = torch.sum(diff * diff, axis=-1, keepdims=True)
    e_in = torch.concatenate([h[dst], h[src], dist2, e_attr], axis=-1)
    m_ij = _silu(e_in @ w_e)
    coord_scale = m_ij @ w_x
    pos_new = pos + _segment_sum(diff * coord_scale, dst, N)
    m_i = _segment_sum(m_ij, dst, N)
    h_new = h + _silu(torch.concatenate([h, m_i], axis=-1) @ w_h)
    return h_new, pos_new
```

```asm
; @launch kernel=egnn_prep_kernel grid=(234,1,1) block=(1024,1,1) lds=66560
; @launch kernel=egnn_edge_kernel grid=(250,1,1) block=(1024,1,1) lds=160768
.amdgcn_target "amdgcn-amd-amdhsa--gfx950"
.text
.globl egnn_prep_kernel
.p2align 8
.type egnn_prep_kernel,@function
egnn_prep_kernel:
    s_cmp_ge_u32 s2, 234
    s_cbranch_scc1 K1_END
    s_load_dwordx16 s[16:31], s[0:1], 0
    s_load_dwordx4 s[32:35], s[0:1], 64
    s_load_dwordx2 s[36:37], s[0:1], 80
    s_cmp_lt_u32 s2, 64
    s_cbranch_scc1 K1_BIN
    s_cmp_lt_u32 s2, 221
    s_cbranch_scc1 K1_GEMM
    s_getpc_b64 s[92:93]
K1_PCL2:
    s_add_u32 s92, s92, egnn_edge_kernel-K1_PCL2
    s_addc_u32 s93, s93, 0
    v_lshlrev_b32 v99, 7, v0
    v_cmp_gt_u32 vcc, K2_END-egnn_edge_kernel+4, v99
    s_and_saveexec_b64 s[70:71], vcc
    s_cbranch_execz K1_PF4
    global_load_dword v100, v99, s[92:93]
K1_PF4:
    s_mov_b64 exec, s[70:71]
    s_cmp_lt_u32 s2, 227
    s_cbranch_scc1 K1_TR
    s_cmp_lt_u32 s2, 232
    s_cbranch_scc1 K1_P8
    s_cmp_eq_u32 s2, 233
    s_cbranch_scc1 K1_TAB
    s_branch K1_WDE
K1_BIN:
    v_mov_b32 v4, -1
    v_mov_b32 v5, -1
    v_mov_b32 v6, -1
    v_mov_b32 v7, -1
    v_lshlrev_b32 v3, 4, v0
    v_lshlrev_b32 v1, 2, v0
    v_lshlrev_b32 v2, 1, v0
    v_mov_b32 v8, 0
    v_cmp_gt_u32 vcc, 257, v0
    s_and_saveexec_b64 s[70:71], vcc
    ds_write_b32 v1, v8 offset:32768
    s_mov_b64 exec, s[70:71]
    ds_write_b128 v3, v[4:7]
    v_cmp_gt_u32 vcc, 976, v0
    s_mov_b64 s[66:67], vcc
    s_mov_b64 exec, vcc
    ds_write_b128 v3, v[4:7] offset:16384
    s_mov_b64 exec, -1
    s_mul_i32 s60, s2, 10000
    s_add_u32 s61, s60, 4096
    s_add_u32 s62, s60, 8192
    s_mul_i32 s63, s2, 5000
    s_add_u32 s64, s63, 4096
    s_waitcnt lgkmcnt(0)
    s_mov_b32 s40, s24
    s_mov_b32 s41, s25
    s_mov_b32 s42, 640000
    s_mov_b32 s43, 0x20000
    s_mov_b32 s44, s22
    s_mov_b32 s45, s23
    s_mov_b32 s46, 640000
    s_mov_b32 s47, 0x20000
    s_mov_b32 s48, s20
    s_mov_b32 s49, s21
    s_mov_b32 s50, 320000
    s_mov_b32 s51, 0x20000
    v_cmp_gt_u32 vcc, 452, v0
    s_mov_b64 s[68:69], vcc
    buffer_load_dword v10, v1, s[40:43], s60 offen
    buffer_load_dword v11, v1, s[40:43], s61 offen
    s_mov_b64 exec, s[68:69]
    buffer_load_dword v12, v1, s[40:43], s62 offen
    s_mov_b64 exec, -1
    buffer_load_dword v15, v1, s[44:47], s60 offen
    buffer_load_dword v16, v1, s[44:47], s61 offen
    s_mov_b64 exec, s[68:69]
    buffer_load_dword v17, v1, s[44:47], s62 offen
    s_mov_b64 exec, -1
    buffer_load_short_d16_hi v41, v2, s[48:51], s63 offen offset:0
    buffer_load_short_d16_hi v43, v2, s[48:51], s63 offen offset:2048
    s_mov_b64 exec, s[68:69]
    buffer_load_short_d16_hi v45, v2, s[48:51], s64 offen offset:0
    s_mov_b64 exec, -1
    s_add_u32 s52, s36, 3145728
    s_addc_u32 s53, s37, 0
    s_mov_b32 s54, 2048000
    s_mov_b32 s55, 0x20000
    s_add_u32 s56, s36, 10485760
    s_addc_u32 s57, s37, 0
    s_mov_b32 s58, 2560000
    s_mov_b32 s59, 0x20000
    s_add_u32 s72, s36, 2752512
    s_addc_u32 s73, s37, 0
    s_mov_b32 s74, 256
    s_mov_b32 s75, 0x20000
    v_lshrrev_b32 v9, 3, v0
    v_and_b32 v7, 7, v0
    v_add_u32 v8, v7, v9
    v_and_b32 v8, 7, v8
    v_lshlrev_b32 v8, 4, v8
    v_lshl_add_u32 v60, v9, 7, v8
    v_mul_u32_u24 v63, 8192, v9
    v_lshl_add_u32 v63, v7, 4, v63
    s_lshl_b32 s77, s2, 7
    s_add_u32 s78, s77, 1048576
    s_mov_b32 s79, 0xfff00000
    s_barrier
    s_mov_b32 s65, 52429
    v_mov_b32 v6, 1
    s_waitcnt vmcnt(8)
    v_mul_u32_u24 v25, s65, v10
    v_lshrrev_b32 v25, 21, v25
    v_mul_u32_u24 v7, 40, v25
    v_sub_u32 v10, v10, v7
    v_lshlrev_b32 v30, 2, v25
    ds_add_rtn_u32 v35, v30, v6 offset:32768
    s_waitcnt vmcnt(7)
    v_mul_u32_u24 v26, s65, v11
    v_lshrrev_b32 v26, 21, v26
    v_mul_u32_u24 v7, 40, v26
    v_sub_u32 v11, v11, v7
    v_lshlrev_b32 v31, 2, v26
    ds_add_rtn_u32 v36, v31, v6 offset:32768
    s_waitcnt vmcnt(6)
    v_mul_u32_u24 v27, s65, v12
    v_lshrrev_b32 v27, 21, v27
    v_mul_u32_u24 v7, 40, v27
    v_sub_u32 v12, v12, v7
    v_lshlrev_b32 v32, 2, v27
    s_mov_b64 exec, s[68:69]
    ds_add_rtn_u32 v37, v32, v6 offset:32768
    s_mov_b64 exec, -1
    v_mul_u32_u24 v7, 13, v10
    v_lshrrev_b32 v7, 6, v7
    v_mul_u32_u24 v8, 5, v7
    v_sub_u32 v8, v10, v8
    v_lshl_or_b32 v8, v7, 3, v8
    s_waitcnt vmcnt(5)
    v_lshl_or_b32 v40, v15, 6, v8
    v_mul_u32_u24 v7, 13, v11
    v_lshrrev_b32 v7, 6, v7
    v_mul_u32_u24 v8, 5, v7
    v_sub_u32 v8, v11, v8
    v_lshl_or_b32 v8, v7, 3, v8
    s_waitcnt vmcnt(4)
    v_lshl_or_b32 v42, v16, 6, v8
    v_mul_u32_u24 v7, 13, v12
    v_lshrrev_b32 v7, 6, v7
    v_mul_u32_u24 v8, 5, v7
    v_sub_u32 v8, v12, v8
    v_lshl_or_b32 v8, v7, 3, v8
    s_waitcnt vmcnt(3)
    v_lshl_or_b32 v44, v17, 6, v8
    s_waitcnt vmcnt(2)
    v_and_or_b32 v40, v41, s79, v40
    v_bfe_u32 v50, v41, 16, 4
    v_xor_b32 v50, 15, v50
    s_waitcnt vmcnt(1)
    v_and_or_b32 v42, v43, s79, v42
    v_bfe_u32 v51, v43, 16, 4
    v_xor_b32 v51, 15, v51
    s_waitcnt vmcnt(0)
    v_and_or_b32 v44, v45, s79, v44
    v_bfe_u32 v52, v45, 16, 4
    v_xor_b32 v52, 15, v52
    s_waitcnt lgkmcnt(1)
    v_cmp_gt_u32 vcc, 28, v35
    v_lshl_add_u32 v7, v25, 1, v35
    v_and_b32 v7, 15, v7
    v_lshlrev_b32 v8, 7, v25
    v_lshl_add_u32 v7, v7, 3, v8
    v_lshrrev_b32 v9, 4, v35
    v_lshl_add_u32 v7, v9, 2, v7
    v_bfe_u32 v54, v35, 2, 2
    v_lshl_add_u32 v54, v25, 1, v54
    v_add_u32 v54, 12, v54
    v_and_b32 v54, 15, v54
    v_lshl_add_u32 v54, v54, 3, v8
    v_and_b32 v55, 3, v35
    v_lshlrev_b32 v55, 1, v55
    v_add_u32 v55, v55, v9
    v_lshlrev_b32 v55, 2, v55
    v_lshlrev_b32 v55, v55, v50
    s_mov_b64 exec, vcc
    ds_write_b32 v7, v40
    ds_xor_b32 v54, v55 offset:4
    s_not_b64 exec, vcc
    s_cbranch_execz K1_NOV_1
    v_mov_b32 v9, 33792
    ds_add_rtn_u32 v8, v9, v6
    s_mul_i32 s76, s2, 40000
    v_mov_b32 v56, v40
    v_mov_b32 v57, v41
    v_mov_b32 v58, v25
    v_mov_b32 v59, 0
    s_waitcnt lgkmcnt(0)
    v_lshlrev_b32 v8, 4, v8
    buffer_store_dwordx4 v[56:59], v8, s[56:59], s76 offen
    s_nop 1
K1_NOV_1:
    s_mov_b64 exec, -1
    s_waitcnt lgkmcnt(2)
    v_cmp_gt_u32 vcc, 28, v36
    v_lshl_add_u32 v7, v26, 1, v36
    v_and_b32 v7, 15, v7
    v_lshlrev_b32 v8, 7, v26
    v_lshl_add_u32 v7, v7, 3, v8
    v_lshrrev_b32 v9, 4, v36
    v_lshl_add_u32 v7, v9, 2, v7
    v_bfe_u32 v54, v36, 2, 2
    v_lshl_add_u32 v54, v26, 1, v54
    v_add_u32 v54, 12, v54
    v_and_b32 v54, 15, v54
    v_lshl_add_u32 v54, v54, 3, v8
    v_and_b32 v55, 3, v36
    v_lshlrev_b32 v55, 1, v55
    v_add_u32 v55, v55, v9
    v_lshlrev_b32 v55, 2, v55
    v_lshlrev_b32 v55, v55, v51
    s_mov_b64 exec, vcc
    ds_write_b32 v7, v42
    ds_xor_b32 v54, v55 offset:4
    s_not_b64 exec, vcc
    s_cbranch_execz K1_NOV_2
    v_mov_b32 v9, 33792
    ds_add_rtn_u32 v8, v9, v6
    s_mul_i32 s76, s2, 40000
    v_mov_b32 v56, v42
    v_mov_b32 v57, v43
    v_mov_b32 v58, v26
    v_mov_b32 v59, 0
    s_waitcnt lgkmcnt(0)
    v_lshlrev_b32 v8, 4, v8
    buffer_store_dwordx4 v[56:59], v8, s[56:59], s76 offen
    s_nop 1
K1_NOV_2:
    s_mov_b64 exec, -1
    s_waitcnt lgkmcnt(4)
    v_cmp_gt_u32 vcc, 28, v37
    s_and_b64 vcc, vcc, s[68:69]
    v_lshl_add_u32 v7, v27, 1, v37
    v_and_b32 v7, 15, v7
    v_lshlrev_b32 v8, 7, v27
    v_lshl_add_u32 v7, v7, 3, v8
    v_lshrrev_b32 v9, 4, v37
    v_lshl_add_u32 v7, v9, 2, v7
    v_bfe_u32 v54, v37, 2, 2
    v_lshl_add_u32 v54, v27, 1, v54
    v_add_u32 v54, 12, v54
    v_and_b32 v54, 15, v54
    v_lshl_add_u32 v54, v54, 3, v8
    v_and_b32 v55, 3, v37
    v_lshlrev_b32 v55, 1, v55
    v_add_u32 v55, v55, v9
    v_lshlrev_b32 v55, 2, v55
    v_lshlrev_b32 v55, v55, v52
    s_mov_b64 exec, vcc
    ds_write_b32 v7, v44
    ds_xor_b32 v54, v55 offset:4
    s_andn2_b64 exec, s[68:69], vcc
    s_cbranch_execz K1_NOV_3
    v_mov_b32 v9, 33792
    ds_add_rtn_u32 v8, v9, v6
    s_mul_i32 s76, s2, 40000
    v_mov_b32 v56, v44
    v_mov_b32 v57, v45
    v_mov_b32 v58, v27
    v_mov_b32 v59, 0
    s_waitcnt lgkmcnt(0)
    v_lshlrev_b32 v8, 4, v8
    buffer_store_dwordx4 v[56:59], v8, s[56:59], s76 offen
    s_nop 1
K1_NOV_3:
    s_mov_b64 exec, -1
    s_waitcnt lgkmcnt(0)
    s_barrier
    ds_read_b128 v[64:67], v60
    ds_read_b128 v[68:71], v60 offset:16384
    v_mov_b32 v9, 33792
    ds_read_b32 v8, v9
    s_waitcnt lgkmcnt(2)
    buffer_store_dwordx4 v[64:67], v63, s[52:55], s77 offen sc1
    s_waitcnt lgkmcnt(1)
    s_mov_b64 exec, s[66:67]
    buffer_store_dwordx4 v[68:71], v63, s[52:55], s78 offen sc1
    s_mov_b64 exec, -1
    s_waitcnt lgkmcnt(0)
    v_cmp_eq_u32 vcc, 0, v0
    s_and_saveexec_b64 s[70:71], vcc
    s_cbranch_execz K1_BIN_SK2
    s_lshl_b32 s77, s2, 2
    v_mov_b32 v9, 0
    buffer_store_dword v8, v9, s[72:75], s77 offen sc1
K1_BIN_SK2:
    s_mov_b64 exec, s[70:71]
    s_endpgm
K1_GEMM:
    s_sub_u32 s3, s2, 64
    v_and_b32 v1, 63, v0
    v_lshrrev_b32 v2, 6, v0
    v_lshrrev_b32 v3, 4, v1
    v_readfirstlane_b32 s4, v2
    v_and_b32 v4, 15, v1
    v_lshlrev_b32 v5, 2, v3
    v_xor_b32 v5, v5, v4
    v_lshlrev_b32 v5, 4, v5
    v_lshl_add_u32 v5, v3, 8, v5
    s_and_b32 s10, s4, 3
    s_lshl_b32 s10, s10, 2
    v_or_b32 v6, s10, v3
    v_xor_b32 v6, v6, v4
    v_lshlrev_b32 v6, 4, v6
    v_lshl_add_u32 v6, v3, 8, v6
    s_lshl_b32 s5, s4, 10
    s_mul_i32 s8, s3, 16384
    s_add_u32 s9, s8, s5
    s_lshl_b32 s6, s4, 11
    s_add_u32 s7, s6, 32768
    s_waitcnt lgkmcnt(0)
    s_mov_b32 s44, s16
    s_mov_b32 s45, s17
    s_mov_b32 s46, 2560000
    s_mov_b32 s47, 0x20000
    s_mov_b32 s40, s26
    s_mov_b32 s41, s27
    s_mov_b32 s42, 66048
    s_mov_b32 s43, 0x20000
    s_add_u32 m0, s5, 32768
    s_nop 0
    buffer_load_dwordx4 v6, s[44:47], s9 offen lds
    s_add_u32 m0, s6, 0
    s_nop 0
    buffer_load_dwordx4 v5, s[40:43], s7 offen lds
    s_add_u32 s7, s7, 1024
    s_add_u32 m0, s6, 1024
    s_nop 0
    buffer_load_dwordx4 v5, s[40:43], s7 offen lds
    s_add_u32 s7, s7, 1024
    s_mov_b32 s48, s36
    s_mov_b32 s49, s37
    s_mov_b32 s50, 2560000
    s_mov_b32 s51, 0x20000
    s_and_b32 s12, s4, 3
    s_lshr_b32 s13, s4, 2
    v_and_b32 v4, 31, v1
    v_lshrrev_b32 v5, 5, v1
    v_and_b32 v7, 15, v1
    v_lshrrev_b32 v8, 2, v7
    v_and_b32 v9, 3, v7
    v_lshl_add_u32 v10, v5, 3, v8
    v_lshlrev_b32 v10, 8, v10
    v_and_b32 v11, 1, v9
    v_lshlrev_b32 v11, 5, v11
    v_lshrrev_b32 v12, 1, v9
    v_lshl_add_u32 v11, v12, 3, v11
    v_bfe_u32 v12, v1, 4, 1
    v_lshl_add_u32 v11, v12, 4, v11
    v_xor_b32 v12, s12, v8
    v_lshl_add_u32 v11, v12, 6, v11
    v_add_u32 v10, v10, v11
    v_and_b32 v11, 15, v4
    v_xor_b32 v11, v11, v5
    v_lshlrev_b32 v11, 4, v11
    v_lshl_add_u32 v11, v4, 8, v11
    s_lshl_b32 s14, s13, 13
    s_add_u32 s15, s14, 32768
    v_add_u32 v11, s15, v11
    v_and_b32 v12, 15, v4
    v_lshlrev_b32 v13, 1, v5
    s_lshl_b32 s15, s12, 2
    v_add_u32 v13, s15, v13
    v_xor_b32 v13, v13, v12
    v_lshlrev_b32 v13, 4, v13
    v_lshl_add_u32 v13, v4, 8, v13
    s_add_u32 s14, s14, 49152
    v_add_u32 v13, s14, v13
    v_xor_b32 v14, 16, v13
    v_lshlrev_b32 v15, 4, v1
    s_add_u32 s14, s5, 49152
    v_add_u32 v15, s14, v15
    s_mov_b32 s14, 3216550459
    s_mov_b32 s15, 3216550459
    s_waitcnt vmcnt(0)
    s_barrier
    s_cmp_ge_u32 s4, 8
    s_cbranch_scc1 K1_G2
    ds_read_b64_tr_b16 v[32:33], v10 offset:0
    ds_read_b64_tr_b16 v[34:35], v10 offset:1024
    ds_read_b64_tr_b16 v[36:37], v10 offset:4096
    ds_read_b64_tr_b16 v[38:39], v10 offset:5120
    ds_read_b64_tr_b16 v[40:41], v10 offset:8192
    ds_read_b64_tr_b16 v[42:43], v10 offset:9216
    ds_read_b64_tr_b16 v[44:45], v10 offset:12288
    ds_read_b64_tr_b16 v[46:47], v10 offset:13312
    ds_read_b64_tr_b16 v[48:49], v10 offset:16384
    ds_read_b64_tr_b16 v[50:51], v10 offset:17408
    ds_read_b64_tr_b16 v[52:53], v10 offset:20480
    ds_read_b64_tr_b16 v[54:55], v10 offset:21504
    ds_read_b64_tr_b16 v[56:57], v10 offset:24576
    ds_read_b64_tr_b16 v[58:59], v10 offset:25600
    ds_read_b64_tr_b16 v[60:61], v10 offset:28672
    ds_read_b64_tr_b16 v[62:63], v10 offset:29696
    ds_read_b128 v[64:67], v11
    v_xor_b32 v12, 32, v11
    ds_read_b128 v[68:71], v12
    v_xor_b32 v12, 64, v11
    ds_read_b128 v[72:75], v12
    v_xor_b32 v12, 96, v11
    ds_read_b128 v[76:79], v12
    v_xor_b32 v12, 128, v11
    ds_read_b128 v[80:83], v12
    v_xor_b32 v12, 160, v11
    ds_read_b128 v[84:87], v12
    v_xor_b32 v12, 192, v11
    ds_read_b128 v[88:91], v12
    v_xor_b32 v12, 224, v11
    ds_read_b128 v[92:95], v12
    s_waitcnt lgkmcnt(7)
    v_mfma_f32_32x32x16_bf16 v[96:111], v[32:35], v[64:67], 0
    s_waitcnt lgkmcnt(6)
    v_mfma_f32_32x32x16_bf16 v[96:111], v[36:39], v[68:71], v[96:111]
    s_waitcnt lgkmcnt(5)
    v_mfma_f32_32x32x16_bf16 v[96:111], v[40:43], v[72:75], v[96:111]
    s_waitcnt lgkmcnt(4)
    v_mfma_f32_32x32x16_bf16 v[96:111], v[44:47], v[76:79], v[96:111]
    s_waitcnt lgkmcnt(3)
    v_mfma_f32_32x32x16_bf16 v[96:111], v[48:51], v[80:83], v[96:111]
    s_waitcnt lgkmcnt(2)
    v_mfma_f32_32x32x16_bf16 v[96:111], v[52:55], v[84:87], v[96:111]
    s_waitcnt lgkmcnt(1)
    v_mfma_f32_32x32x16_bf16 v[96:111], v[56:59], v[88:91], v[96:111]
    s_waitcnt lgkmcnt(0)
    v_mfma_f32_32x32x16_bf16 v[96:111], v[60:63], v[92:95], v[96:111]
    s_nop 7
    s_nop 3
    v_pk_mul_f32 v[96:97], v[96:97], s[14:15]
    v_pk_mul_f32 v[98:99], v[98:99], s[14:15]
    v_pk_mul_f32 v[100:101], v[100:101], s[14:15]
    v_pk_mul_f32 v[102:103], v[102:103], s[14:15]
    v_pk_mul_f32 v[104:105], v[104:105], s[14:15]
    v_pk_mul_f32 v[106:107], v[106:107], s[14:15]
    v_pk_mul_f32 v[108:109], v[108:109], s[14:15]
    v_pk_mul_f32 v[110:111], v[110:111], s[14:15]
    v_cvt_pk_bf16_f32 v32, v96, v97
    v_cvt_pk_bf16_f32 v33, v98, v99
    v_cvt_pk_bf16_f32 v34, v100, v101
    v_cvt_pk_bf16_f32 v35, v102, v103
    v_cvt_pk_bf16_f32 v36, v104, v105
    v_cvt_pk_bf16_f32 v37, v106, v107
    v_cvt_pk_bf16_f32 v38, v108, v109
    v_cvt_pk_bf16_f32 v39, v110, v111
    ds_write_b128 v13, v[32:35]
    ds_write_b128 v14, v[36:39]
K1_G2:
    s_waitcnt lgkmcnt(0)
    s_barrier
    ds_read_b128 v[32:35], v15
    s_waitcnt lgkmcnt(0)
    buffer_store_dwordx4 v[32:35], v6, s[48:51], s9 offen sc1
    s_endpgm
K1_TR:
    s_sub_u32 s3, s2, 221
    v_and_b32 v1, 63, v0
    v_lshrrev_b32 v2, 8, v0
    s_lshl_b32 s4, s3, 2
    v_add_u32 v2, s4, v2
    v_and_b32 v4, 7, v2
    v_bfe_u32 v5, v0, 6, 2
    v_lshlrev_b32 v6, 5, v5
    v_lshrrev_b32 v7, 4, v1
    v_lshl_add_u32 v6, v7, 3, v6
    v_lshlrev_b32 v6, 8, v6
    v_lshrrev_b32 v7, 1, v4
    v_lshlrev_b32 v7, 5, v7
    v_bfe_u32 v8, v1, 2, 2
    v_lshl_add_u32 v7, v8, 3, v7
    v_and_b32 v8, 1, v4
    v_lshl_add_u32 v7, v8, 2, v7
    v_and_b32 v8, 3, v1
    v_add_u32 v7, v8, v7
    v_lshl_add_u32 v6, v7, 1, v6
    s_lshr_b32 s5, s3, 1
    s_waitcnt lgkmcnt(0)
    s_cmp_eq_u32 s5, 0
    s_cselect_b32 s40, s26, s30
    s_cselect_b32 s41, s27, s31
    s_mov_b32 s42, 65536
    s_mov_b32 s43, 0x20000
    s_cmp_eq_u32 s5, 2
    s_cselect_b32 s6, 32768, 0
    s_add_u32 s44, s36, 2621440
    s_addc_u32 s45, s37, 0
    s_mov_b32 s46, 98304
    s_mov_b32 s47, 0x20000
    v_add_u32 v6, s6, v6
    buffer_load_ushort v16, v6, s[40:43], 0 offen offset:0
    buffer_load_ushort v17, v6, s[40:43], 0 offen offset:256
    buffer_load_ushort v18, v6, s[40:43], 0 offen offset:512
    buffer_load_ushort v19, v6, s[40:43], 0 offen offset:768
    buffer_load_ushort v20, v6, s[40:43], 0 offen offset:1024
    buffer_load_ushort v21, v6, s[40:43], 0 offen offset:1280
    buffer_load_ushort v22, v6, s[40:43], 0 offen offset:1536
    buffer_load_ushort v23, v6, s[40:43], 0 offen offset:1792
    v_lshlrev_b32 v5, 4, v0
    s_lshl_b32 s9, s3, 14
    s_waitcnt vmcnt(0)
    v_lshl_or_b32 v8, v17, 16, v16
    v_lshl_or_b32 v9, v19, 16, v18
    v_lshl_or_b32 v10, v21, 16, v20
    v_lshl_or_b32 v11, v23, 16, v22
    buffer_store_dwordx4 v[8:11], v5, s[44:47], s9 offen sc1
    s_endpgm
K1_P8:
    s_sub_u32 s3, s2, 227
    s_lshl_b32 s3, s3, 10
    v_add_u32 v1, s3, v0
    v_cmp_gt_u32 vcc, 5000, v1
    s_and_saveexec_b64 s[70:71], vcc
    s_cbranch_execz K1_END
    v_mul_u32_u24 v2, 12, v1
    v_lshlrev_b32 v3, 4, v1
    s_waitcnt lgkmcnt(0)
    s_mov_b32 s40, s18
    s_mov_b32 s41, s19
    s_mov_b32 s42, 60000
    s_mov_b32 s43, 0x20000
    s_add_u32 s44, s36, 2818048
    s_addc_u32 s45, s37, 0
    s_mov_b32 s46, 80000
    s_mov_b32 s47, 0x20000
    buffer_load_dwordx3 v[4:6], v2, s[40:43], 0 offen
    s_waitcnt vmcnt(0)
    v_alignbit_b32 v10, v6, v5, 16
    v_lshrrev_b32 v11, 16, v6
    v_mov_b32 v8, v4
    v_and_b32 v9, 0xffff, v5
    buffer_store_dwordx4 v[8:11], v3, s[44:47], 0 offen sc1
    s_endpgm
K1_TAB:
    v_and_b32 v1, 63, v0
    v_lshrrev_b32 v2, 6, v0
    v_and_b32 v3, 31, v1
    v_readfirstlane_b32 s4, v2
    v_lshrrev_b32 v4, 5, v1
    v_lshlrev_b32 v4, 1, v4
    v_lshrrev_b32 v5, 2, v3
    v_and_b32 v6, 3, v3
    v_and_b32 v7, 15, v1
    v_lshrrev_b32 v8, 4, v1
    s_lshr_b32 s5, s4, 2
    s_and_b32 s6, s4, 1
    s_lshl_b32 s7, s4, 2
    s_and_b32 s7, s7, 8
    s_lshl_b32 s8, s4, 12
    s_add_u32 s8, s8, 94848
    v_cmp_eq_u32 s[10:11], 0, v6
    v_lshl_add_u32 v9, v6, 1, v5
    v_or_b32 v10, s7, v4
    s_xor_b32 s12, s6, 0
    s_lshl_b32 s13, s5, 1
    s_add_u32 s12, s12, s13
    s_mul_i32 s12, s12, 5
    v_add_u32 v11, s12, v5
    v_min_u32 v11, 39, v11
    v_xor_b32 v12, v11, v10
    v_and_b32 v12, 15, v12
    v_lshlrev_b32 v12, 4, v12
    v_lshl_add_u32 v12, v11, 8, v12
    v_add_u32 v12, 84608, v12
    v_add_u32 v13, s12, v9
    v_xor_b32 v13, v13, v4
    v_and_b32 v13, 7, v13
    v_lshlrev_b32 v13, 4, v13
    v_lshl_add_u32 v13, v3, 7, v13
    v_add_u32 v13, s8, v13
    v_cndmask_b32 v20, v13, v12, s[10:11]
    s_xor_b32 s12, s6, 1
    s_lshl_b32 s13, s5, 1
    s_add_u32 s12, s12, s13
    s_mul_i32 s12, s12, 5
    v_add_u32 v11, s12, v5
    v_min_u32 v11, 39, v11
    v_xor_b32 v12, v11, v10
    v_and_b32 v12, 15, v12
    v_lshlrev_b32 v12, 4, v12
    v_lshl_add_u32 v12, v11, 8, v12
    v_add_u32 v12, 84608, v12
    v_add_u32 v13, s12, v9
    v_xor_b32 v13, v13, v4
    v_and_b32 v13, 7, v13
    v_lshlrev_b32 v13, 4, v13
    v_lshl_add_u32 v13, v3, 7, v13
    v_add_u32 v13, s8, v13
    v_cndmask_b32 v24, v13, v12, s[10:11]
    v_lshlrev_b32 v14, 8, v7
    v_lshl_add_u32 v14, v8, 4, v14
    v_xor_b32 v15, v8, v7
    v_lshlrev_b32 v15, 4, v15
    v_lshl_add_u32 v15, v7, 8, v15
    v_add_u32 v15, 62464, v15
    v_lshlrev_b32 v16, 4, v1
    s_lshl_b32 s9, s4, 12
    s_waitcnt lgkmcnt(0)
    s_add_u32 s44, s36, 2949120
    s_addc_u32 s45, s37, 0
    s_mov_b32 s46, 66560
    s_mov_b32 s47, 0x20000
    s_cmp_ge_u32 s4, 8
    s_cbranch_scc1 K1_TABH
    s_lshr_b32 s12, s4, 1
    s_lshl_b32 s12, s12, 6
    s_lshl_b32 s13, s6, 3
    s_or_b32 s12, s12, s13
    s_xor_b32 s12, s12, 128
    v_xor_b32 v21, s12, v15
    v_cmp_le_u32 vcc, 8, v7
    v_subrev_u32 v22, 2048, v14
    v_mov_b32 v23, v14
    v_cndmask_b32 v22, 0, v22, vcc
    v_mov_b32 v25, v21
    v_mov_b32 v26, v22
    v_mov_b32 v27, v23
    buffer_store_dwordx4 v[20:23], v16, s[44:47], s9 offen sc1
    buffer_store_dwordx4 v[24:27], v16, s[44:47], s9 offen offset:1024 sc1
    s_cmp_eq_u32 s4, 0
    s_cbranch_scc0 K1_END
    v_xor_b32 v28, 128, v15
    v_xor_b32 v29, 192, v15
    v_mov_b32 v30, v15
    v_xor_b32 v31, 64, v15
    s_mov_b32 s9, 65536
    buffer_store_dwordx4 v[28:31], v16, s[44:47], s9 offen sc1
    s_endpgm
K1_TABH:
    s_sub_u32 s12, s4, 8
    s_lshr_b32 s12, s12, 1
    s_lshl_b32 s13, s6, 4
    v_add_u32 v17, s13, v7
    v_min_u32 v11, 29, v17
    v_mul_u32_u24 v12, 171, v11
    v_lshrrev_b32 v12, 9, v12
    s_mul_i32 s13, s12, 60
    v_lshl_add_u32 v23, v17, 1, s13
    s_mul_i32 s13, s12, 80
    s_add_u32 s13, s13, 160448
    v_add_u32 v22, v11, v12
    v_lshl_add_u32 v22, v22, 1, s13
    v_mul_u32_u24 v13, 3, v12
    v_sub_u32 v13, v11, v13
    v_add_u32 v13, 1, v13
    s_mul_i32 s13, s12, 10
    v_add_u32 v12, s13, v12
    v_mul_u32_u24 v18, 13, v12
    v_lshrrev_b32 v18, 6, v18
    v_mul_u32_u24 v19, 5, v18
    v_sub_u32 v19, v12, v19
    v_lshl_add_u32 v19, v19, 2, v13
    v_lshlrev_b32 v19, 7, v19
    v_lshrrev_b32 v36, 1, v18
    v_lshl_add_u32 v19, v36, 14, v19
    v_lshl_add_u32 v36, v13, 1, v12
    v_xor_b32 v36, v36, v8
    v_and_b32 v36, 7, v36
    v_lshl_add_u32 v19, v36, 4, v19
    v_add_u32 v19, 94848, v19
    v_and_b32 v18, 1, v18
    v_lshl_add_u32 v21, v18, 12, v19
    v_xor_b32 v18, 1, v18
    v_lshl_add_u32 v29, v18, 12, v19
    v_mov_b32 v25, v21
    v_mov_b32 v26, v22
    v_mov_b32 v27, v23
    v_mov_b32 v28, v20
    v_mov_b32 v30, v22
    v_mov_b32 v31, v23
    v_mov_b32 v32, v24
    v_mov_b32 v33, v29
    v_mov_b32 v34, v22
    v_mov_b32 v35, v23
    buffer_store_dwordx4 v[20:23], v16, s[44:47], s9 offen offset:0 sc1
    buffer_store_dwordx4 v[24:27], v16, s[44:47], s9 offen offset:1024 sc1
    buffer_store_dwordx4 v[28:31], v16, s[44:47], s9 offen offset:2048 sc1
    buffer_store_dwordx4 v[32:35], v16, s[44:47], s9 offen offset:3072 sc1
    s_endpgm
K1_WDE:
    v_cmp_gt_u32 vcc, 256, v0
    s_and_saveexec_b64 s[70:71], vcc
    s_cbranch_execz K1_END
    v_lshlrev_b32 v1, 1, v0
    s_waitcnt lgkmcnt(0)
    s_mov_b32 s40, s26
    s_mov_b32 s41, s27
    s_mov_b32 s42, 66048
    s_mov_b32 s43, 0x20000
    s_add_u32 s44, s36, 2719744
    s_addc_u32 s45, s37, 0
    s_mov_b32 s46, 1024
    s_mov_b32 s47, 0x20000
    s_mov_b32 s10, 65536
    buffer_load_short_d16_hi v2, v1, s[40:43], s10 offen
    s_mov_b32 s11, 3216550459
    s_waitcnt vmcnt(0)
    v_mul_f32 v2, s11, v2
    v_cvt_pk_bf16_f32 v3, v2, v2
    v_lshlrev_b32 v4, 16, v3
    v_sub_f32 v4, v2, v4
    v_cvt_pk_bf16_f32 v4, v4, v4
    buffer_store_short v3, v1, s[44:47], 0 offen sc1
    buffer_store_short v4, v1, s[44:47], 0 offen offset:512 sc1
K1_END:
    s_endpgm
.section .rodata,"a"
.p2align 6
.amdhsa_kernel egnn_prep_kernel
  .amdhsa_next_free_vgpr 128
  .amdhsa_next_free_sgpr 102
  .amdhsa_accum_offset 128
  .amdhsa_group_segment_fixed_size 0
  .amdhsa_kernarg_size 88
  .amdhsa_user_sgpr_count 2
  .amdhsa_user_sgpr_kernarg_segment_ptr 1
  .amdhsa_system_sgpr_workgroup_id_x 1
.end_amdhsa_kernel
.text

.globl egnn_edge_kernel
.p2align 8
.type egnn_edge_kernel,@function
egnn_edge_kernel:
    s_cmp_ge_u32 s2, 250
    s_cbranch_scc1 K2_END
    s_load_dwordx16 s[16:31], s[0:1], 0
    s_load_dwordx4 s[32:35], s[0:1], 64
    s_load_dwordx2 s[36:37], s[0:1], 80
    v_lshrrev_b32 v11, 6, v0
    v_and_b32 v1, 63, v0
    v_readfirstlane_b32 s4, v11
    v_mov_b32 v16, 0
    v_mov_b32 v17, 0
    v_mov_b32 v18, 0
    v_mov_b32 v19, 0
    v_lshlrev_b32 v13, 4, v0
    ds_write_b128 v13, v[16:19] offset:0
    ds_write_b128 v13, v[16:19] offset:16384
    ds_write_b128 v13, v[16:19] offset:32768
    s_cmp_ge_u32 s4, 12
    s_cbranch_scc1 K2_Z_4
    ds_write_b128 v13, v[16:19] offset:49152
K2_Z_4:
    s_cmp_lg_u32 s4, 15
    s_cbranch_scc1 K2_Z_5
    v_lshlrev_b32 v13, 4, v1
    s_mov_b32 exec_hi, 0xffff
    ds_write_b128 v13, v[16:19] offset:61440
    s_mov_b64 exec, -1
K2_Z_5:
    s_and_b32 s5, s4, 3
    s_lshr_b32 s6, s5, 1
    s_lshr_b32 s7, s4, 2
    s_xor_b32 s13, s7, s4
    s_and_b32 s13, s13, 1
    s_lshl_b32 s7, s7, 1
    s_lshl_b32 s9, s4, 12
    s_add_u32 s9, s9, 94848
    v_lshlrev_b32 v19, 3, v0
    v_lshlrev_b32 v15, 4, v1
    v_lshlrev_b32 v13, 2, v1
    s_mul_i32 s8, s2, 8192
    s_mul_i32 s78, s2, 320
    s_waitcnt lgkmcnt(0)
    s_add_u32 s40, s36, 3145728
    s_addc_u32 s41, s37, 0
    s_mov_b32 s42, 2048000
    s_mov_b32 s43, 0x20000
    buffer_load_dwordx2 v[8:9], v19, s[40:43], s8 offen
    s_add_u32 s44, s36, 2752512
    s_addc_u32 s45, s37, 0
    s_mov_b32 s46, 256
    s_mov_b32 s47, 0x20000
    buffer_load_dword v120, v13, s[44:47], 0 offen
    s_mov_b32 s48, s36
    s_mov_b32 s49, s37
    s_mov_b32 s50, 2560000
    s_mov_b32 s51, 0x20000
    s_barrier
    s_add_u32 s56, s36, 2621440
    s_addc_u32 s57, s37, 0
    s_mov_b32 s58, 394240
    s_mov_b32 s59, 0x20000
    s_add_u32 s64, s36, 2818048
    s_addc_u32 s65, s37, 0
    s_mov_b32 s66, 80000
    s_mov_b32 s67, 0x20000
    s_and_b32 s5, s4, 3
    s_cmp_ge_u32 s4, 8
    s_cbranch_scc1 K2_JA
    s_cmp_lt_u32 s4, 4
    s_cbranch_scc1 K2_J3
    s_mov_b32 s52, s16
    s_mov_b32 s53, s17
    s_mov_b32 s54, 2560000
    s_mov_b32 s55, 0x20000
    s_mul_i32 s10, s2, 10240
    v_lshrrev_b32 v16, 4, v1
    v_and_b32 v18, 15, v1
    v_xor_b32 v17, v16, v18
    v_lshlrev_b32 v17, 4, v17
    v_lshl_add_u32 v17, v16, 8, v17
    s_cmp_eq_u32 s4, 5
    s_cbranch_scc1 K2_JH5
    s_cmp_eq_u32 s4, 6
    s_cbranch_scc1 K2_JH6
    s_cmp_eq_u32 s4, 7
    s_cbranch_scc1 K2_JH7
    s_add_u32 s11, s10, 0
    s_mov_b32 m0, 74368
    s_nop 0
    buffer_load_dwordx4 v17, s[52:55], s11 offen lds
    v_xor_b32 v18, 64, v17
    s_add_u32 s11, s10, 1024
    s_mov_b32 m0, 75392
    s_nop 0
    buffer_load_dwordx4 v18, s[52:55], s11 offen lds
    v_xor_b32 v18, 128, v17
    s_add_u32 s11, s10, 2048
    s_mov_b32 m0, 76416
    s_nop 0
    buffer_load_dwordx4 v18, s[52:55], s11 offen lds
    s_branch K2_J3
K2_JH5:
    v_xor_b32 v18, 192, v17
    s_add_u32 s11, s10, 3072
    s_mov_b32 m0, 77440
    s_nop 0
    buffer_load_dwordx4 v18, s[52:55], s11 offen lds
    s_add_u32 s11, s10, 4096
    s_mov_b32 m0, 78464
    s_nop 0
    buffer_load_dwordx4 v17, s[52:55], s11 offen lds
    v_xor_b32 v18, 64, v17
    s_add_u32 s11, s10, 5120
    s_mov_b32 m0, 79488
    s_nop 0
    buffer_load_dwordx4 v18, s[52:55], s11 offen lds
    s_branch K2_J3
K2_JH6:
    v_xor_b32 v18, 128, v17
    s_add_u32 s11, s10, 6144
    s_mov_b32 m0, 80512
    s_nop 0
    buffer_load_dwordx4 v18, s[52:55], s11 offen lds
    v_xor_b32 v18, 192, v17
    s_add_u32 s11, s10, 7168
    s_mov_b32 m0, 81536
    s_nop 0
    buffer_load_dwordx4 v18, s[52:55], s11 offen lds
    s_mov_b32 m0, 160448
    s_mov_b64 exec, 0xfffff
    buffer_load_dwordx4 v15, s[64:67], s78 offen lds
    s_mov_b64 exec, -1
    s_branch K2_J3
K2_JH7:
    s_add_u32 s11, s10, 8192
    s_mov_b32 m0, 82560
    s_nop 0
    buffer_load_dwordx4 v17, s[52:55], s11 offen lds
    v_xor_b32 v18, 64, v17
    s_add_u32 s11, s10, 9216
    s_mov_b32 m0, 83584
    s_nop 0
    buffer_load_dwordx4 v18, s[52:55], s11 offen lds
    s_branch K2_J3
K2_JA:
    s_lshl_b32 s10, s5, 13
    s_lshl_b32 s11, s4, 10
    s_and_b32 s11, s11, 4096
    s_add_u32 s10, s10, s11
    buffer_load_dwordx4 v[72:75], v15, s[56:59], s10 offen offset:0
    buffer_load_dwordx4 v[76:79], v15, s[56:59], s10 offen offset:1024
    buffer_load_dwordx4 v[80:83], v15, s[56:59], s10 offen offset:2048
    buffer_load_dwordx4 v[84:87], v15, s[56:59], s10 offen offset:3072
    s_cmp_lt_u32 s4, 12
    s_cbranch_scc1 K2_J3
    s_cmp_eq_u32 s4, 14
    s_cbranch_scc1 K2_JX
    s_cmp_eq_u32 s4, 15
    s_cbranch_scc1 K2_JW
    s_mov_b32 s72, s32
    s_mov_b32 s73, s33
    s_mov_b32 s74, 2620000
    s_mov_b32 s75, 0x20000
    s_mul_i32 s10, s2, 10240
    s_mul_i32 s11, s2, 240
    s_add_u32 s11, s11, 2560000
    s_cmp_eq_u32 s4, 12
    s_cselect_b32 s10, s10, s11
    v_mov_b32 v13, 0
    s_mov_b64 exec, 1
    buffer_load_dword v127, v13, s[72:75], s10 offen
    s_mov_b64 exec, -1
    s_branch K2_J3
K2_JX:
    s_mov_b32 s72, s28
    s_mov_b32 s73, s29
    s_mov_b32 s74, 256
    s_mov_b32 s75, 0x20000
    s_mov_b32 m0, 62208
    s_mov_b64 exec, 0xffff
    buffer_load_dwordx4 v15, s[72:75], 0 offen lds
    s_mov_b64 exec, -1
    s_branch K2_J3
K2_JW:
    s_add_u32 s72, s36, 2719744
    s_addc_u32 s73, s37, 0
    s_mov_b32 s74, 1024
    s_mov_b32 s75, 0x20000
    s_mov_b32 m0, 73344
    s_nop 0
    buffer_load_dwordx4 v15, s[72:75], 0 offen lds
    s_branch K2_J3
K2_J3:
    s_mov_b32 s68, s32
    s_mov_b32 s69, s33
    s_mov_b32 s70, 2620000
    s_mov_b32 s71, 0x20000
    s_mov_b32 s77, 0x003fff00
    s_mov_b32 s76, 1
    s_mov_b32 s79, 160448
    v_and_b32 v13, 31, v1
    v_lshrrev_b32 v14, 5, v1
    v_bfe_u32 v15, v13, 2, 1
    v_lshlrev_b32 v15, 4, v15
    v_lshrrev_b32 v16, 3, v13
    v_lshl_add_u32 v15, v16, 2, v15
    v_and_b32 v16, 3, v13
    v_add_u32 v15, v15, v16
    v_lshlrev_b32 v15, 1, v15
    v_lshl_add_u32 v15, v14, 9, v15
    v_add_u32 v2, s9, v15
    s_lshl_b32 s10, s7, 11
    s_add_u32 s10, s10, 40960
    v_lshlrev_b32 v15, 4, v13
    v_add_u32 v3, s10, v15
    s_mul_i32 s10, s7, 5120
    v_bfe_u32 v15, v1, 2, 2
    v_lshl_add_u32 v15, v14, 2, v15
    v_mul_u32_u24 v15, 40, v15
    v_bfe_u32 v16, v1, 4, 1
    v_lshl_add_u32 v15, v16, 5, v15
    v_and_b32 v16, 3, v1
    v_lshl_add_u32 v15, v16, 3, v15
    v_add_u32 v4, s10, v15
    s_lshl_b32 s10, s7, 9
    s_add_u32 s10, s10, 57344
    v_lshrrev_b32 v15, 3, v1
    v_lshlrev_b32 v15, 2, v15
    v_add_u32 v5, s10, v15
    s_lshl_b32 s11, s6, 7
    v_and_b32 v15, 7, v1
    v_lshlrev_b32 v15, 4, v15
    v_add_u32 v6, s11, v15
    v_and_b32 v16, 15, v1
    v_lshrrev_b32 v17, 2, v16
    v_and_b32 v16, 3, v16
    v_and_b32 v18, 1, v16
    v_lshlrev_b32 v18, 5, v18
    v_lshrrev_b32 v16, 1, v16
    v_lshl_add_u32 v18, v16, 3, v18
    v_bfe_u32 v16, v1, 4, 1
    v_lshl_add_u32 v18, v16, 4, v18
    s_lshl_b32 s10, s6, 7
    v_add_u32 v18, s10, v18
    s_mul_i32 s11, s7, 1360
    v_cmp_lt_u32 vcc, 31, v1
    v_cmp_gt_u32 s[80:81], 2, v17
    v_cmp_gt_u32 s[82:83], 3, v17
    s_add_u32 s12, s11, 61920
    v_mul_u32_u24 v13, 272, v17
    v_add_u32 v13, s12, v13
    v_lshlrev_b32 v14, 8, v17
    v_add_u32 v15, 73344, v14
    v_cndmask_b32 v13, v13, v15, s[80:81]
    v_add_u32 v15, 73856, v14
    v_mov_b32 v16, 61568
    v_cndmask_b32 v15, v16, v15, s[80:81]
    v_cndmask_b32 v13, v13, v15, vcc
    v_add_u32 v124, v13, v18
    s_add_u32 s12, s11, 63008
    v_mul_u32_u24 v13, 272, v17
    v_add_u32 v13, s12, v13
    v_cndmask_b32 v13, v16, v13, s[82:83]
    v_cndmask_b32 v13, v13, v16, vcc
    v_add_u32 v125, v13, v18
    v_mov_b32 v38, 1360
    v_cndmask_b32 v39, 0, v38, s[82:83]
    v_cndmask_b32 v38, v38, 0, s[80:81]
    v_cndmask_b32 v39, v39, 0, vcc
    v_cndmask_b32 v38, v38, 0, vcc
    v_and_b32 v36, 3, v1
    v_lshlrev_b32 v36, 3, v36
    v_and_b32 v37, 7, v1
    v_lshlrev_b32 v37, 3, v37
    s_mov_b32 s92, 0
    v_mov_b32 v88, 0
    v_mov_b32 v89, 0
    v_mov_b32 v90, 0
    v_mov_b32 v91, 0
    v_mov_b32 v92, 0
    v_mov_b32 v93, 0
    v_mov_b32 v94, 0
    v_mov_b32 v95, 0
    v_mov_b32 v96, 0
    v_mov_b32 v97, 0
    v_mov_b32 v98, 0
    v_mov_b32 v99, 0
    v_mov_b32 v100, 0
    v_mov_b32 v101, 0
    v_mov_b32 v102, 0
    v_mov_b32 v103, 0
    v_mov_b32 v104, 0
    v_mov_b32 v105, 0
    v_mov_b32 v106, 0
    v_mov_b32 v107, 0
    v_mov_b32 v108, 0
    v_mov_b32 v109, 0
    v_mov_b32 v110, 0
    v_mov_b32 v111, 0
    s_cmp_ge_u32 s4, 8
    s_cbranch_scc1 K2_W9
    v_mov_b32 v112, 0
    v_mov_b32 v113, 0
    v_mov_b32 v114, 0
    v_mov_b32 v115, 0
    v_mov_b32 v116, 0
    v_mov_b32 v117, 0
    v_mov_b32 v118, 0
    v_mov_b32 v119, 0
    s_cmp_eq_u32 s4, 7
    s_cbranch_scc1 K2_W3
    s_cmp_ge_u32 s4, 4
    s_cbranch_scc1 K2_W4
    s_waitcnt vmcnt(1)
    s_branch K2_WD
K2_W3:
    s_waitcnt vmcnt(3)
    s_branch K2_WD
K2_W4:
    s_waitcnt vmcnt(4)
    s_branch K2_WD
K2_W9:
    v_and_b32 v118, 15, v1
    v_lshrrev_b32 v119, 4, v1
    v_xor_b32 v117, v119, v118
    v_lshlrev_b32 v117, 4, v117
    v_lshl_add_u32 v112, v118, 8, v117
    v_add_u32 v112, 62464, v112
    v_xor_b32 v113, 64, v112
    v_xor_b32 v114, 128, v112
    v_xor_b32 v115, 192, v112
    v_mul_u32_u24 v116, 272, v118
    v_lshl_add_u32 v116, v119, 4, v116
    s_lshl_b32 s10, s5, 6
    s_lshl_b32 s11, s4, 1
    s_and_b32 s11, s11, 8
    s_add_u32 s10, s10, s11
    s_add_u32 s10, s10, 62464
    v_add_u32 v116, s10, v116
    v_cmp_gt_u32 s[86:87], 8, v118
    s_mov_b32 s88, 3216550459
    s_mov_b32 s89, 3216550459
    s_cmp_ge_u32 s4, 12
    s_cbranch_scc1 K2_W2R
    s_waitcnt vmcnt(5)
    s_branch K2_WD
K2_W2R:
    s_waitcnt vmcnt(6)
K2_WD:
    s_mov_b32 s82, 0x0fff0fff
    s_mov_b32 s83, 0x0fff0fff
    v_mov_b32_dpp v16, v9 row_newbcast:12 row_mask:0xf bank_mask:0x1
    v_mov_b32_dpp v16, v9 row_newbcast:13 row_mask:0xf bank_mask:0x2
    v_mov_b32_dpp v16, v9 row_newbcast:14 row_mask:0xf bank_mask:0x4
    v_mov_b32_dpp v16, v9 row_newbcast:15 row_mask:0xf bank_mask:0x8
    v_cndmask_b32 v10, -1, v9, s[82:83]
    v_cmp_ne_u32 vcc, -1, v8
    v_lshrrev_b32 v16, v36, v16
    v_cmp_ne_u32 s[84:85], -1, v10
    v_and_b32 v9, 0xfff00000, v8
    v_and_b32 v17, 15, v16
    v_cndmask_b32 v7, 0, 1, vcc
    v_lshl_or_b32 v9, v17, 16, v9
    s_cmp_eq_u64 s[84:85], 0
    s_cbranch_scc1 K2_ROUND
    v_and_b32 v11, 0xfff00000, v10
    v_bfe_u32 v17, v16, 4, 4
    v_lshl_or_b32 v11, v17, 16, v11
    v_cndmask_b32 v13, 0, 2, s[84:85]
    v_or_b32 v7, v7, v13
K2_ROUND:
    v_mov_b32 v12, 1
    v_and_b32 v13, 1, v7
    v_cmp_ne_u32 s[80:81], 0, v13
    s_lshr_b32 s10, s4, 2
    s_cmp_lg_u64 s[84:85], 0
    s_mov_b64 exec, s[80:81]
    s_cbranch_scc1 K2_P1B
    v_and_b32 v14, 0x38, v8
    ds_add_rtn_u32 v16, v14, v12 offset:61440
    v_bfe_u32 v13, v8, 6, 14
    v_lshlrev_b32 v13, 3, v13
    v_and_b32 v15, 7, v8
    buffer_load_dwordx2 v[56:57], v13, s[64:67], 0 offen
    v_lshl_add_u32 v15, v15, 3, s79
    v_mad_u32_u24 v58, v14, 5, v15
    s_waitcnt lgkmcnt(0)
    v_cmp_gt_u32 vcc, 128, v16
    v_lshl_add_u32 v121, v14, 4, v16
    v_lshlrev_b32 v15, 2, v8
    s_and_b64 exec, exec, vcc
    s_mov_b64 s[96:97], exec
    v_lshlrev_b32 v13, 2, v121
    ds_write_b32 v13, v15 offset:57344
    v_and_b32 v15, 7, v8
    v_lshlrev_b32 v13, 3, v121
    v_add_lshl_u32 v13, v13, v15, 1
    v_mov_b32 v15, 0x3f80
    ds_write_b16 v13, v15 offset:40964
    v_and_b32 v7, 2, v7
    s_mov_b64 exec, -1
    s_cmp_eq_u32 s10, 1
    s_cbranch_scc0 K2_RH
    s_cmp_eq_u64 s[80:81], 0
    s_cbranch_scc1 K2_RH0
    s_waitcnt vmcnt(1)
    s_branch K2_RH
K2_P1B:
    v_and_b32 v14, 0x38, v8
    ds_add_rtn_u32 v16, v14, v12 offset:61440
    v_bfe_u32 v13, v8, 6, 14
    v_lshlrev_b32 v13, 3, v13
    v_and_b32 v15, 7, v8
    buffer_load_dwordx2 v[56:57], v13, s[64:67], 0 offen
    v_lshl_add_u32 v15, v15, 3, s79
    v_mad_u32_u24 v58, v14, 5, v15
    s_mov_b64 exec, s[84:85]
    v_and_b32 v18, 0x38, v10
    ds_add_rtn_u32 v17, v18, v12 offset:61440
    v_bfe_u32 v13, v10, 6, 14
    v_lshlrev_b32 v13, 3, v13
    v_and_b32 v15, 7, v10
    buffer_load_dwordx2 v[60:61], v13, s[64:67], 0 offen
    v_lshl_add_u32 v15, v15, 3, s79
    v_mad_u32_u24 v62, v18, 5, v15
    s_mov_b64 exec, s[80:81]
    s_waitcnt lgkmcnt(0)
    v_cmp_gt_u32 vcc, 128, v16
    v_lshl_add_u32 v121, v14, 4, v16
    v_lshlrev_b32 v15, 2, v8
    s_and_b64 exec, exec, vcc
    s_mov_b64 s[96:97], exec
    v_lshlrev_b32 v13, 2, v121
    ds_write_b32 v13, v15 offset:57344
    v_and_b32 v15, 7, v8
    v_lshlrev_b32 v13, 3, v121
    v_add_lshl_u32 v13, v13, v15, 1
    v_mov_b32 v15, 0x3f80
    ds_write_b16 v13, v15 offset:40964
    v_and_b32 v7, 2, v7
    s_mov_b64 exec, s[84:85]
    v_cmp_gt_u32 vcc, 128, v17
    v_lshl_add_u32 v122, v18, 4, v17
    v_lshlrev_b32 v15, 2, v10
    s_and_b64 exec, exec, vcc
    s_mov_b64 s[98:99], exec
    v_lshlrev_b32 v13, 2, v122
    ds_write_b32 v13, v15 offset:57344
    v_and_b32 v15, 7, v10
    v_lshlrev_b32 v13, 3, v122
    v_add_lshl_u32 v13, v13, v15, 1
    v_mov_b32 v15, 0x3f80
    ds_write_b16 v13, v15 offset:40964
    v_and_b32 v7, 1, v7
    s_mov_b64 exec, -1
    s_cmp_eq_u32 s10, 1
    s_cbranch_scc0 K2_RH
    s_cmp_eq_u64 s[80:81], 0
    s_cbranch_scc1 K2_RH0
    s_waitcnt vmcnt(2)
    s_branch K2_RH
K2_RH0:
    s_waitcnt vmcnt(0)
K2_RH:
    s_waitcnt lgkmcnt(0)
    s_barrier
    s_mov_b32 s95, 0
    s_mov_b64 exec, s[96:97]
    ds_read_b64 v[58:59], v58
    s_cmp_eq_u64 s[84:85], 0
    s_cbranch_scc1 K2_PD1
    s_mov_b64 exec, s[98:99]
    ds_read_b64 v[62:63], v62
K2_PD1:
    s_mov_b64 exec, -1
    s_cmp_eq_u32 s76, 0
    s_cbranch_scc1 K2_LATER
    s_cmp_ge_u32 s4, 8
    s_cbranch_scc1 K2_HW
    ds_read_b32 v14, v37 offset:61440
    s_add_u32 s12, s7, 1
    ds_read2_b32 v[48:49], v5 offset0:0 offset1:128
    ds_read2_b32 v[50:51], v5 offset0:8 offset1:136
    ds_read2_b32 v[52:53], v5 offset0:16 offset1:144
    ds_read2_b32 v[54:55], v5 offset0:24 offset1:152
    v_lshlrev_b32 v44, 4, v121
    v_mul_u32_u24 v16, 40, v121
    v_and_b32 v17, 7, v8
    v_lshl_add_u32 v46, v17, 3, v16
    s_waitcnt lgkmcnt(0)
    v_readlane_b32 s10, v14, s7
    v_readlane_b32 s11, v14, s12
    s_mov_b32 s95, 1
    s_cmp_gt_u32 s11, s10
    s_cselect_b32 s10, 1, 0
    s_xor_b32 s13, s13, s10
    s_cbranch_scc1 K2_O1
    v_and_or_b32 v40, v48, s77, v6
    v_and_or_b32 v41, v50, s77, v6
    v_and_or_b32 v42, v52, s77, v6
    v_and_or_b32 v43, v54, s77, v6
    s_branch K2_O2
K2_O1:
    v_and_or_b32 v40, v49, s77, v6
    v_and_or_b32 v41, v51, s77, v6
    v_and_or_b32 v42, v53, s77, v6
    v_and_or_b32 v43, v55, s77, v6
K2_O2:
    s_add_u32 m0, s9, 0
    s_nop 0
    buffer_load_dwordx4 v40, s[48:51], 0 offen lds
    s_add_u32 m0, s9, 1024
    s_nop 0
    buffer_load_dwordx4 v41, s[48:51], 0 offen lds
    s_add_u32 m0, s9, 2048
    s_nop 0
    buffer_load_dwordx4 v42, s[48:51], 0 offen lds
    s_add_u32 m0, s9, 3072
    s_nop 0
    buffer_load_dwordx4 v43, s[48:51], 0 offen lds
    s_waitcnt vmcnt(4)
    v_lshlrev_b32 v64, 16, v58
    v_and_b32 v65, 0xffff0000, v58
    v_lshlrev_b32 v66, 16, v56
    v_and_b32 v67, 0xffff0000, v56
    v_lshlrev_b32 v68, 16, v59
    v_lshlrev_b32 v69, 16, v57
    v_pk_add_f32 v[64:65], v[64:65], v[66:67] neg_lo:[0,1] neg_hi:[0,1]
    v_sub_f32 v68, v68, v69
    v_cvt_pk_bf16_f32 v70, v64, v65
    v_cvt_pk_bf16_f32 v71, v68, v68
    v_lshlrev_b32 v64, 16, v70
    v_and_b32 v65, 0xffff0000, v70
    v_lshlrev_b32 v66, 16, v71
    v_or_b32 v68, 0x3f80, v64
    v_mul_f32 v64, v64, v64
    v_alignbit_b32 v69, v71, v70, 16
    v_fma_f32 v64, v65, v65, v64
    v_fma_f32 v64, v66, v66, v64
    v_cvt_pk_bf16_f32 v64, v64, v9
    s_mov_b64 exec, s[96:97]
    ds_write_b64 v46, v[68:69] offset:0
    ds_write_b32 v44, v64 offset:40960
    s_mov_b64 exec, -1
    s_cmp_eq_u64 s[84:85], 0
    s_cbranch_scc1 K2_XB_6
    v_lshlrev_b32 v44, 4, v122
    v_mul_u32_u24 v16, 40, v122
    v_and_b32 v17, 7, v10
    v_lshl_add_u32 v46, v17, 3, v16
    v_lshlrev_b32 v64, 16, v62
    v_and_b32 v65, 0xffff0000, v62
    v_lshlrev_b32 v66, 16, v60
    v_and_b32 v67, 0xffff0000, v60
    v_lshlrev_b32 v68, 16, v63
    v_lshlrev_b32 v69, 16, v61
    v_pk_add_f32 v[64:65], v[64:65], v[66:67] neg_lo:[0,1] neg_hi:[0,1]
    v_sub_f32 v68, v68, v69
    v_cvt_pk_bf16_f32 v70, v64, v65
    v_cvt_pk_bf16_f32 v71, v68, v68
    v_lshlrev_b32 v64, 16, v70
    v_and_b32 v65, 0xffff0000, v70
    v_lshlrev_b32 v66, 16, v71
    v_or_b32 v68, 0x3f80, v64
    v_mul_f32 v64, v64, v64
    v_alignbit_b32 v69, v71, v70, 16
    v_fma_f32 v64, v65, v65, v64
    v_fma_f32 v64, v66, v66, v64
    v_cvt_pk_bf16_f32 v64, v64, v11
    s_mov_b64 exec, s[98:99]
    ds_write_b64 v46, v[68:69] offset:0
    ds_write_b32 v44, v64 offset:40960
    s_mov_b64 exec, -1
K2_XB_6:
    s_add_u32 s7, s7, s13
    s_lshl_b32 s10, s13, 11
    s_mul_i32 s11, s13, 5120
    s_lshl_b32 s12, s13, 9
    v_add_u32 v3, s10, v3
    v_add_u32 v4, s11, v4
    v_add_u32 v5, s12, v5
    v_mad_u32_u24 v124, v38, s13, v124
    v_mad_u32_u24 v125, v39, s13, v125
    s_cmp_eq_u32 s4, 4
    s_cbranch_scc0 K2_C3
    v_mov_b32_dpp v15, v14 quad_perm:[1,0,3,2] row_mask:0xf bank_mask:0xf
    v_cmp_gt_u32 vcc, v15, v14
    v_sad_u32 v15, v14, v15, 0
    v_bfe_u32 v18, v1, 1, 1
    v_cndmask_b32 v17, 0, 1, vcc
    v_sub_u32_dpp v16, v15, v15 quad_perm:[2,3,0,1] row_mask:0xf bank_mask:0xf
    v_xor_b32 v17, v17, v18
    v_bfe_u32 v18, v1, 2, 1
    v_readlane_b32 s10, v16, 0
    v_readlane_b32 s11, v16, 4
    s_mul_i32 s10, s10, s11
    s_cmp_gt_i32 s10, 0
    s_cselect_b32 s10, 1, 0
    v_and_b32 v18, s10, v18
    v_xor_b32 v17, v17, v18
    v_lshlrev_b32 v13, 1, v1
    v_add_u32 v13, 160384, v13
    s_mov_b64 exec, 0x55
    ds_write_b32 v13, v17
    s_mov_b64 exec, -1
    s_branch K2_C3
K2_HW:
    v_lshlrev_b32 v44, 4, v121
    v_mul_u32_u24 v16, 40, v121
    v_and_b32 v17, 7, v8
    v_lshl_add_u32 v46, v17, 3, v16
    s_waitcnt vmcnt(0) lgkmcnt(0)
    v_lshlrev_b32 v64, 16, v58
    v_and_b32 v65, 0xffff0000, v58
    v_lshlrev_b32 v66, 16, v56
    v_and_b32 v67, 0xffff0000, v56
    v_lshlrev_b32 v68, 16, v59
    v_lshlrev_b32 v69, 16, v57
    v_pk_add_f32 v[64:65], v[64:65], v[66:67] neg_lo:[0,1] neg_hi:[0,1]
    v_sub_f32 v68, v68, v69
    v_cvt_pk_bf16_f32 v70, v64, v65
    v_cvt_pk_bf16_f32 v71, v68, v68
    v_lshlrev_b32 v64, 16, v70
    v_and_b32 v65, 0xffff0000, v70
    v_lshlrev_b32 v66, 16, v71
    v_or_b32 v68, 0x3f80, v64
    v_mul_f32 v64, v64, v64
    v_alignbit_b32 v69, v71, v70, 16
    v_fma_f32 v64, v65, v65, v64
    v_fma_f32 v64, v66, v66, v64
    v_cvt_pk_bf16_f32 v64, v64, v9
    s_mov_b64 exec, s[96:97]
    ds_write_b64 v46, v[68:69] offset:0
    ds_write_b32 v44, v64 offset:40960
    s_mov_b64 exec, -1
    s_cmp_eq_u64 s[84:85], 0
    s_cbranch_scc1 K2_XB_7
    v_lshlrev_b32 v44, 4, v122
    v_mul_u32_u24 v16, 40, v122
    v_and_b32 v17, 7, v10
    v_lshl_add_u32 v46, v17, 3, v16
    v_lshlrev_b32 v64, 16, v62
    v_and_b32 v65, 0xffff0000, v62
    v_lshlrev_b32 v66, 16, v60
    v_and_b32 v67, 0xffff0000, v60
    v_lshlrev_b32 v68, 16, v63
    v_lshlrev_b32 v69, 16, v61
    v_pk_add_f32 v[64:65], v[64:65], v[66:67] neg_lo:[0,1] neg_hi:[0,1]
    v_sub_f32 v68, v68, v69
    v_cvt_pk_bf16_f32 v70, v64, v65
    v_cvt_pk_bf16_f32 v71, v68, v68
    v_lshlrev_b32 v64, 16, v70
    v_and_b32 v65, 0xffff0000, v70
    v_lshlrev_b32 v66, 16, v71
    v_or_b32 v68, 0x3f80, v64
    v_mul_f32 v64, v64, v64
    v_alignbit_b32 v69, v71, v70, 16
    v_fma_f32 v64, v65, v65, v64
    v_fma_f32 v64, v66, v66, v64
    v_cvt_pk_bf16_f32 v64, v64, v11
    s_mov_b64 exec, s[98:99]
    ds_write_b64 v46, v[68:69] offset:0
    ds_write_b32 v44, v64 offset:40960
    s_mov_b64 exec, -1
K2_XB_7:
    s_branch K2_C3
K2_LATER:
    v_lshlrev_b32 v44, 4, v121
    v_mul_u32_u24 v16, 40, v121
    v_and_b32 v17, 7, v8
    v_lshl_add_u32 v46, v17, 3, v16
    s_waitcnt vmcnt(0) lgkmcnt(0)
    v_lshlrev_b32 v64, 16, v58
    v_and_b32 v65, 0xffff0000, v58
    v_lshlrev_b32 v66, 16, v56
    v_and_b32 v67, 0xffff0000, v56
    v_lshlrev_b32 v68, 16, v59
    v_lshlrev_b32 v69, 16, v57
    v_pk_add_f32 v[64:65], v[64:65], v[66:67] neg_lo:[0,1] neg_hi:[0,1]
    v_sub_f32 v68, v68, v69
    v_cvt_pk_bf16_f32 v70, v64, v65
    v_cvt_pk_bf16_f32 v71, v68, v68
    v_lshlrev_b32 v64, 16, v70
    v_and_b32 v65, 0xffff0000, v70
    v_lshlrev_b32 v66, 16, v71
    v_or_b32 v68, 0x3f80, v64
    v_mul_f32 v64, v64, v64
    v_alignbit_b32 v69, v71, v70, 16
    v_fma_f32 v64, v65, v65, v64
    v_fma_f32 v64, v66, v66, v64
    v_cvt_pk_bf16_f32 v64, v64, v9
    s_mov_b64 exec, s[96:97]
    ds_write_b64 v46, v[68:69] offset:0
    ds_write_b32 v44, v64 offset:40960
    s_mov_b64 exec, -1
    s_cmp_eq_u64 s[84:85], 0
    s_cbranch_scc1 K2_XB_8
    v_lshlrev_b32 v44, 4, v122
    v_mul_u32_u24 v16, 40, v122
    v_and_b32 v17, 7, v10
    v_lshl_add_u32 v46, v17, 3, v16
    v_lshlrev_b32 v64, 16, v62
    v_and_b32 v65, 0xffff0000, v62
    v_lshlrev_b32 v66, 16, v60
    v_and_b32 v67, 0xffff0000, v60
    v_lshlrev_b32 v68, 16, v63
    v_lshlrev_b32 v69, 16, v61
    v_pk_add_f32 v[64:65], v[64:65], v[66:67] neg_lo:[0,1] neg_hi:[0,1]
    v_sub_f32 v68, v68, v69
    v_cvt_pk_bf16_f32 v70, v64, v65
    v_cvt_pk_bf16_f32 v71, v68, v68
    v_lshlrev_b32 v64, 16, v70
    v_and_b32 v65, 0xffff0000, v70
    v_lshlrev_b32 v66, 16, v71
    v_or_b32 v68, 0x3f80, v64
    v_mul_f32 v64, v64, v64
    v_alignbit_b32 v69, v71, v70, 16
    v_fma_f32 v64, v65, v65, v64
    v_fma_f32 v64, v66, v66, v64
    v_cvt_pk_bf16_f32 v64, v64, v11
    s_mov_b64 exec, s[98:99]
    ds_write_b64 v46, v[68:69] offset:0
    ds_write_b32 v44, v64 offset:40960
    s_mov_b64 exec, -1
K2_XB_8:
K2_C3:
    v_cmp_ne_u32 vcc, 0, v7
    s_cbranch_vccz K2_NF
    v_mov_b32 v13, 61504
    s_mov_b64 exec, vcc
    ds_write_b32 v13, v12
    s_mov_b64 exec, -1
K2_NF:
    s_cmp_lt_u32 s4, 8
    s_cbranch_scc1 K2_C4
    s_cmp_eq_u32 s76, 0
    s_cbranch_scc1 K2_C4
    ds_read_b128 v[56:59], v112 offset:11904
    ds_read_b128 v[60:63], v113 offset:11904
    ds_read_b128 v[64:67], v114 offset:11904
    ds_read_b128 v[68:71], v115 offset:11904
    ds_read_b128 v[40:43], v112 offset:16000
    ds_read_b128 v[44:47], v113 offset:16000
    ds_read_b128 v[48:51], v114 offset:16000
    ds_read_b128 v[52:55], v115 offset:16000
    ds_read_b128 v[20:23], v112 offset:20096
    ds_read_b128 v[24:27], v113 offset:20096
    ds_read_b128 v[28:31], v114 offset:20096
    ds_read_b128 v[32:35], v115 offset:20096
    s_waitcnt lgkmcnt(11)
    v_mfma_f32_16x16x32_bf16 v[88:91], v[72:75], v[56:59], 0
    s_waitcnt lgkmcnt(10)
    v_mfma_f32_16x16x32_bf16 v[88:91], v[76:79], v[60:63], v[88:91]
    s_waitcnt lgkmcnt(9)
    v_mfma_f32_16x16x32_bf16 v[88:91], v[80:83], v[64:67], v[88:91]
    s_waitcnt lgkmcnt(8)
    v_mfma_f32_16x16x32_bf16 v[88:91], v[84:87], v[68:71], v[88:91]
    s_waitcnt lgkmcnt(7)
    v_mfma_f32_16x16x32_bf16 v[92:95], v[72:75], v[40:43], 0
    s_waitcnt lgkmcnt(6)
    v_mfma_f32_16x16x32_bf16 v[92:95], v[76:79], v[44:47], v[92:95]
    s_waitcnt lgkmcnt(5)
    v_mfma_f32_16x16x32_bf16 v[92:95], v[80:83], v[48:51], v[92:95]
    s_waitcnt lgkmcnt(4)
    v_mfma_f32_16x16x32_bf16 v[92:95], v[84:87], v[52:55], v[92:95]
    s_waitcnt lgkmcnt(3)
    v_mfma_f32_16x16x32_bf16 v[96:99], v[72:75], v[20:23], 0
    s_waitcnt lgkmcnt(2)
    v_mfma_f32_16x16x32_bf16 v[96:99], v[76:79], v[24:27], v[96:99]
    s_waitcnt lgkmcnt(1)
    v_mfma_f32_16x16x32_bf16 v[96:99], v[80:83], v[28:31], v[96:99]
    s_waitcnt lgkmcnt(0)
    v_mfma_f32_16x16x32_bf16 v[96:99], v[84:87], v[32:35], v[96:99]
    v_pk_mul_f32 v[88:89], v[88:89], s[88:89]
    v_pk_mul_f32 v[90:91], v[90:91], s[88:89]
    v_cvt_pk_bf16_f32 v88, v88, v89
    v_cvt_pk_bf16_f32 v89, v90, v91
    ds_write_b64 v116, v[88:89] offset:0
    v_pk_mul_f32 v[92:93], v[92:93], s[88:89]
    v_pk_mul_f32 v[94:95], v[94:95], s[88:89]
    v_cvt_pk_bf16_f32 v92, v92, v93
    v_cvt_pk_bf16_f32 v93, v94, v95
    ds_write_b64 v116, v[92:93] offset:4352
    s_nop 3
    v_pk_mul_f32 v[96:97], v[96:97], s[88:89]
    v_pk_mul_f32 v[98:99], v[98:99], s[88:89]
    v_cvt_pk_bf16_f32 v96, v96, v97
    v_cvt_pk_bf16_f32 v97, v98, v99
    s_mov_b64 exec, s[86:87]
    ds_write_b64 v116, v[96:97] offset:8704
    s_mov_b64 exec, -1
    s_branch K2_C5
K2_C4:
    v_mov_b32 v40, 0
    v_mov_b32 v41, 0
    v_mov_b32 v42, 0
    v_mov_b32 v43, 0
    v_mov_b32 v44, 0
    v_mov_b32 v45, 0
    v_mov_b32 v46, 0
    v_mov_b32 v47, 0
K2_C5:
    s_waitcnt lgkmcnt(0)
    s_barrier
    s_cmp_eq_u32 s76, 0
    s_cbranch_scc1 K2_D2
    s_cmp_lt_u32 s4, 8
    s_cbranch_scc1 K2_D2
    v_mov_b32 v13, 160384
    ds_read_b128 v[16:19], v13
    s_and_b32 s13, s4, 1
    s_waitcnt lgkmcnt(0)
    v_readfirstlane_b32 s10, v18
    v_readfirstlane_b32 s11, v19
    v_readfirstlane_b32 s12, v16
    v_readfirstlane_b32 s15, v17
    s_cmp_ge_u32 s4, 12
    s_cselect_b32 s14, s11, s10
    s_cselect_b32 s10, s10, s12
    s_cselect_b32 s11, s11, s15
    s_bitcmp1_b32 s4, 1
    s_cselect_b32 s15, s11, s10
    s_xor_b32 s13, s13, s14
    s_add_u32 s7, s7, s13
    s_lshl_b32 s10, s13, 11
    s_mul_i32 s11, s13, 5120
    s_lshl_b32 s12, s13, 9
    v_add_u32 v3, s10, v3
    v_add_u32 v4, s11, v4
    v_add_u32 v5, s12, v5
    v_mad_u32_u24 v124, v38, s13, v124
    v_mad_u32_u24 v125, v39, s13, v125
    v_mov_b32 v88, 0
    v_mov_b32 v89, 0
    v_mov_b32 v90, 0
    v_mov_b32 v91, 0
    v_mov_b32 v92, 0
    v_mov_b32 v93, 0
    v_mov_b32 v94, 0
    v_mov_b32 v95, 0
    v_mov_b32 v96, 0
    v_mov_b32 v97, 0
    v_mov_b32 v98, 0
    v_mov_b32 v99, 0
    v_mov_b32 v112, 0
    v_mov_b32 v113, 0
    v_mov_b32 v114, 0
    v_mov_b32 v115, 0
    v_mov_b32 v116, 0
    v_mov_b32 v117, 0
    v_mov_b32 v118, 0
    v_mov_b32 v119, 0
    v_mov_b32 v40, 0
    v_mov_b32 v41, 0
    v_mov_b32 v42, 0
    v_mov_b32 v43, 0
    v_mov_b32 v44, 0
    v_mov_b32 v45, 0
    v_mov_b32 v46, 0
    v_mov_b32 v47, 0
K2_D2:
    s_lshl_b32 s10, s7, 3
    v_mov_b32 v13, s10
    ds_read_b32 v14, v13 offset:61440
    v_mov_b32 v13, 61504
    ds_read_b32 v16, v13
    ds_read_b64_tr_b16 v[20:21], v124 offset:0
    ds_read_b64_tr_b16 v[22:23], v125 offset:0
    ds_read_b64_tr_b16 v[24:25], v124 offset:64
    ds_read_b64_tr_b16 v[26:27], v125 offset:64
    ds_read_b128 v[28:31], v3
    s_waitcnt lgkmcnt(5)
    v_readfirstlane_b32 s8, v14
    v_readfirstlane_b32 s93, v16
    s_cmp_eq_u32 s76, 0
    s_cbranch_scc1 K2_SKIPY
    v_cmp_ne_u32 vcc, 0, v120
    s_mov_b64 s[90:91], vcc
K2_SKIPY:
    s_cmp_eq_u32 s95, 0
    s_cbranch_scc0 K2_D1
    ds_read_b32 v52, v5 offset:0
    ds_read_b32 v53, v5 offset:32
    ds_read_b32 v54, v5 offset:64
    ds_read_b32 v55, v5 offset:96
    s_waitcnt lgkmcnt(0)
    v_and_or_b32 v52, v52, s77, v6
    v_and_or_b32 v53, v53, s77, v6
    v_and_or_b32 v54, v54, s77, v6
    v_and_or_b32 v55, v55, s77, v6
    s_add_u32 m0, s9, 0
    s_nop 0
    buffer_load_dwordx4 v52, s[48:51], 0 offen lds
    s_add_u32 m0, s9, 1024
    s_nop 0
    buffer_load_dwordx4 v53, s[48:51], 0 offen lds
    s_add_u32 m0, s9, 2048
    s_nop 0
    buffer_load_dwordx4 v54, s[48:51], 0 offen lds
    s_add_u32 m0, s9, 3072
    s_nop 0
    buffer_load_dwordx4 v55, s[48:51], 0 offen lds
K2_D1:
    s_min_u32 s8, s8, 128
    s_cmp_lt_u32 s4, 8
    s_cbranch_scc1 K2_D3
    v_lshlrev_b32 v48, 4, v1
    s_xor_b32 s10, s7, s4
    s_and_b32 s10, s10, 1
    s_lshl_b32 s12, s15, 1
    s_or_b32 s10, s10, s12
    s_lshl_b32 s11, s4, 2
    s_or_b32 s10, s10, s11
    s_lshl_b32 s10, s10, 10
    s_add_u32 s10, s10, 327680
    buffer_load_dwordx4 v[12:15], v48, s[56:59], s10 offen
K2_D3:
    s_cmp_eq_u32 s8, 0
    s_cbranch_scc1 K2_EMPTY
    s_waitcnt vmcnt(0)
    ds_read_u16_d16_hi v56, v2 offset:0
    ds_read_u16_d16_hi v57, v2 offset:128
    ds_read_u16_d16_hi v58, v2 offset:256
    ds_read_u16_d16_hi v59, v2 offset:384
    ds_read_u16_d16_hi v60, v2 offset:1024
    ds_read_u16_d16_hi v61, v2 offset:1152
    ds_read_u16_d16_hi v62, v2 offset:1280
    ds_read_u16_d16_hi v63, v2 offset:1408
    ds_read_u16_d16_hi v64, v2 offset:2048
    ds_read_u16_d16_hi v65, v2 offset:2176
    ds_read_u16_d16_hi v66, v2 offset:2304
    ds_read_u16_d16_hi v67, v2 offset:2432
    ds_read_u16_d16_hi v68, v2 offset:3072
    ds_read_u16_d16_hi v69, v2 offset:3200
    ds_read_u16_d16_hi v70, v2 offset:3328
    ds_read_u16_d16_hi v71, v2 offset:3456
    ds_read_u16_d16_hi v72, v2 offset:64
    ds_read_u16_d16_hi v73, v2 offset:192
    ds_read_u16_d16_hi v74, v2 offset:320
    ds_read_u16_d16_hi v75, v2 offset:448
    ds_read_u16_d16_hi v76, v2 offset:1088
    ds_read_u16_d16_hi v77, v2 offset:1216
    ds_read_u16_d16_hi v78, v2 offset:1344
    ds_read_u16_d16_hi v79, v2 offset:1472
    ds_read_b32 v52, v5 offset:128
    ds_read_b32 v53, v5 offset:160
    ds_read_b32 v54, v5 offset:192
    ds_read_b32 v55, v5 offset:224
    s_waitcnt lgkmcnt(12)
    v_mfma_f32_32x32x16_bf16 v[56:71], v[28:31], v[20:23], v[56:71]
    s_nop 7
    s_cmp_gt_u32 s8, 32
    s_nop 1
    s_cbranch_scc0 K2_LAST
K2_FULL:
    s_setprio 3
    ds_read_u16_d16_hi v80, v2 offset:2112
    ds_read_u16_d16_hi v81, v2 offset:2240
    ds_read_u16_d16_hi v82, v2 offset:2368
    ds_read_u16_d16_hi v83, v2 offset:2496
    ds_read_u16_d16_hi v84, v2 offset:3136
    ds_read_u16_d16_hi v85, v2 offset:3264
    ds_read_u16_d16_hi v86, v2 offset:3392
    ds_read_u16_d16_hi v87, v2 offset:3520
    ds_read_b64_tr_b16 v[32:33], v4 offset:0
    ds_read_b64_tr_b16 v[34:35], v4 offset:320
    ds_read_b64_tr_b16 v[36:37], v4 offset:640
    ds_read_b64_tr_b16 v[38:39], v4 offset:960
    s_sub_u32 s11, s8, 32
    s_add_u32 s12, s11, 7
    s_lshr_b32 s12, s12, 3
    s_min_u32 s12, s12, 4
    s_waitcnt lgkmcnt(12)
    v_and_or_b32 v52, v52, s77, v6
    v_and_or_b32 v53, v53, s77, v6
    v_and_or_b32 v54, v54, s77, v6
    v_and_or_b32 v55, v55, s77, v6
    s_waitcnt lgkmcnt(4)
    s_cmp_le_u32 s12, 0
    s_cbranch_scc1 K2_ND_9
    s_add_u32 m0, s9, 0
    s_nop 0
    buffer_load_dwordx4 v52, s[48:51], 0 offen lds
    s_cmp_le_u32 s12, 1
    s_cbranch_scc1 K2_ND_9
    s_add_u32 m0, s9, 1024
    s_nop 0
    buffer_load_dwordx4 v53, s[48:51], 0 offen lds
    s_cmp_le_u32 s12, 2
    s_cbranch_scc1 K2_ND_9
    s_add_u32 m0, s9, 2048
    s_nop 0
    buffer_load_dwordx4 v54, s[48:51], 0 offen lds
    s_cmp_le_u32 s12, 3
    s_cbranch_scc1 K2_ND_9
    s_add_u32 m0, s9, 3072
    s_nop 0
    buffer_load_dwordx4 v55, s[48:51], 0 offen lds
K2_ND_9:
    v_mfma_f32_32x32x16_bf16 v[72:87], v[28:31], v[24:27], v[72:87]
    v_exp_f32 v48, v56
    v_exp_f32 v49, v57
    v_exp_f32 v50, v58
    v_exp_f32 v51, v59
    v_pk_add_f32 v[48:49], v[48:49], 1.0 op_sel_hi:[1,0]
    v_pk_add_f32 v[50:51], v[50:51], 1.0 op_sel_hi:[1,0]
    v_rcp_f32 v48, v48
    v_rcp_f32 v49, v49
    v_rcp_f32 v50, v50
    v_rcp_f32 v51, v51
    v_pk_mul_f32 v[56:57], v[56:57], v[48:49]
    v_pk_mul_f32 v[58:59], v[58:59], v[50:51]
    v_cvt_pk_bf16_f32 v40, v56, v57
    v_cvt_pk_bf16_f32 v41, v58, v59
    v_exp_f32 v48, v60
    v_exp_f32 v49, v61
    v_exp_f32 v50, v62
    v_exp_f32 v51, v63
    v_pk_add_f32 v[48:49], v[48:49], 1.0 op_sel_hi:[1,0]
    v_pk_add_f32 v[50:51], v[50:51], 1.0 op_sel_hi:[1,0]
    v_rcp_f32 v48, v48
    v_rcp_f32 v49, v49
    v_rcp_f32 v50, v50
    v_rcp_f32 v51, v51
    v_pk_mul_f32 v[60:61], v[60:61], v[48:49]
    v_pk_mul_f32 v[62:63], v[62:63], v[50:51]
    v_cvt_pk_bf16_f32 v42, v60, v61
    v_cvt_pk_bf16_f32 v43, v62, v63
    s_waitcnt lgkmcnt(0)
    s_nop 1
    v_mfma_f32_32x32x16_bf16 v[88:103], v[40:43], v[32:35], v[88:103]
    v_exp_f32 v48, v64
    v_exp_f32 v49, v65
    v_exp_f32 v50, v66
    v_exp_f32 v51, v67
    v_pk_add_f32 v[48:49], v[48:49], 1.0 op_sel_hi:[1,0]
    v_pk_add_f32 v[50:51], v[50:51], 1.0 op_sel_hi:[1,0]
    v_rcp_f32 v48, v48
    v_rcp_f32 v49, v49
    v_rcp_f32 v50, v50
    v_rcp_f32 v51, v51
    v_pk_mul_f32 v[64:65], v[64:65], v[48:49]
    v_pk_mul_f32 v[66:67], v[66:67], v[50:51]
    v_cvt_pk_bf16_f32 v44, v64, v65
    v_cvt_pk_bf16_f32 v45, v66, v67
    v_exp_f32 v48, v68
    v_exp_f32 v49, v69
    v_exp_f32 v50, v70
    v_exp_f32 v51, v71
    v_pk_add_f32 v[48:49], v[48:49], 1.0 op_sel_hi:[1,0]
    v_pk_add_f32 v[50:51], v[50:51], 1.0 op_sel_hi:[1,0]
    v_rcp_f32 v48, v48
    v_rcp_f32 v49, v49
    v_rcp_f32 v50, v50
    v_rcp_f32 v51, v51
    v_pk_mul_f32 v[68:69], v[68:69], v[48:49]
    v_pk_mul_f32 v[70:71], v[70:71], v[50:51]
    v_cvt_pk_bf16_f32 v46, v68, v69
    v_cvt_pk_bf16_f32 v47, v70, v71
    s_nop 1
    v_mfma_f32_32x32x16_bf16 v[88:103], v[44:47], v[36:39], v[88:103]
    s_cmp_gt_u32 s8, 64
    s_cbranch_scc1 K2_PN_11
    s_setprio 2
    s_branch K2_PE_10
K2_PN_11:
    s_setprio 3
K2_PE_10:
    v_exp_f32 v48, v72
    v_exp_f32 v49, v73
    v_exp_f32 v50, v74
    v_exp_f32 v51, v75
    v_pk_add_f32 v[48:49], v[48:49], 1.0 op_sel_hi:[1,0]
    v_pk_add_f32 v[50:51], v[50:51], 1.0 op_sel_hi:[1,0]
    v_rcp_f32 v48, v48
    v_rcp_f32 v49, v49
    v_rcp_f32 v50, v50
    v_rcp_f32 v51, v51
    v_pk_mul_f32 v[72:73], v[72:73], v[48:49]
    v_pk_mul_f32 v[74:75], v[74:75], v[50:51]
    v_cvt_pk_bf16_f32 v40, v72, v73
    v_cvt_pk_bf16_f32 v41, v74, v75
    v_exp_f32 v48, v76
    v_exp_f32 v49, v77
    v_exp_f32 v50, v78
    v_exp_f32 v51, v79
    v_pk_add_f32 v[48:49], v[48:49], 1.0 op_sel_hi:[1,0]
    v_pk_add_f32 v[50:51], v[50:51], 1.0 op_sel_hi:[1,0]
    v_rcp_f32 v48, v48
    v_rcp_f32 v49, v49
    v_rcp_f32 v50, v50
    v_rcp_f32 v51, v51
    v_pk_mul_f32 v[76:77], v[76:77], v[48:49]
    v_pk_mul_f32 v[78:79], v[78:79], v[50:51]
    v_cvt_pk_bf16_f32 v42, v76, v77
    v_cvt_pk_bf16_f32 v43, v78, v79
    s_nop 1
    v_mfma_f32_32x32x16_bf16 v[104:119], v[40:43], v[32:35], v[104:119]
    v_add_u32 v5, 128, v5
    s_waitcnt vmcnt(0)
    ds_read_u16_d16_hi v56, v2 offset:0
    ds_read_u16_d16_hi v57, v2 offset:128
    ds_read_u16_d16_hi v58, v2 offset:256
    ds_read_u16_d16_hi v59, v2 offset:384
    ds_read_u16_d16_hi v60, v2 offset:1024
    ds_read_u16_d16_hi v61, v2 offset:1152
    ds_read_u16_d16_hi v62, v2 offset:1280
    ds_read_u16_d16_hi v63, v2 offset:1408
    ds_read_u16_d16_hi v64, v2 offset:2048
    ds_read_u16_d16_hi v65, v2 offset:2176
    ds_read_u16_d16_hi v66, v2 offset:2304
    ds_read_u16_d16_hi v67, v2 offset:2432
    ds_read_u16_d16_hi v68, v2 offset:3072
    ds_read_u16_d16_hi v69, v2 offset:3200
    ds_read_u16_d16_hi v70, v2 offset:3328
    ds_read_u16_d16_hi v71, v2 offset:3456
    ds_read_b128 v[28:31], v3 offset:512
    ds_read_u16_d16_hi v72, v2 offset:64
    ds_read_u16_d16_hi v73, v2 offset:192
    ds_read_u16_d16_hi v74, v2 offset:320
    ds_read_u16_d16_hi v75, v2 offset:448
    ds_read_u16_d16_hi v76, v2 offset:1088
    ds_read_u16_d16_hi v77, v2 offset:1216
    ds_read_u16_d16_hi v78, v2 offset:1344
    ds_read_u16_d16_hi v79, v2 offset:1472
    ds_read_b32 v52, v5 offset:128
    ds_read_b32 v53, v5 offset:160
    ds_read_b32 v54, v5 offset:192
    ds_read_b32 v55, v5 offset:224
    v_add_u32 v3, 512, v3
    v_add_u32 v4, 1280, v4
    v_exp_f32 v48, v80
    v_exp_f32 v49, v81
    v_exp_f32 v50, v82
    v_exp_f32 v51, v83
    v_pk_add_f32 v[48:49], v[48:49], 1.0 op_sel_hi:[1,0]
    v_pk_add_f32 v[50:51], v[50:51], 1.0 op_sel_hi:[1,0]
    v_rcp_f32 v48, v48
    v_rcp_f32 v49, v49
    v_rcp_f32 v50, v50
    v_rcp_f32 v51, v51
    v_pk_mul_f32 v[80:81], v[80:81], v[48:49]
    v_pk_mul_f32 v[82:83], v[82:83], v[50:51]
    v_cvt_pk_bf16_f32 v44, v80, v81
    v_cvt_pk_bf16_f32 v45, v82, v83
    s_waitcnt lgkmcnt(12)
    v_mfma_f32_32x32x16_bf16 v[56:71], v[28:31], v[20:23], v[56:71]
    v_exp_f32 v48, v84
    v_exp_f32 v49, v85
    v_exp_f32 v50, v86
    v_exp_f32 v51, v87
    v_pk_add_f32 v[48:49], v[48:49], 1.0 op_sel_hi:[1,0]
    v_pk_add_f32 v[50:51], v[50:51], 1.0 op_sel_hi:[1,0]
    v_rcp_f32 v48, v48
    v_rcp_f32 v49, v49
    v_rcp_f32 v50, v50
    v_rcp_f32 v51, v51
    v_pk_mul_f32 v[84:85], v[84:85], v[48:49]
    v_pk_mul_f32 v[86:87], v[86:87], v[50:51]
    v_cvt_pk_bf16_f32 v46, v84, v85
    v_cvt_pk_bf16_f32 v47, v86, v87
    s_nop 1
    v_mfma_f32_32x32x16_bf16 v[104:119], v[44:47], v[36:39], v[104:119]
    s_mov_b32 s8, s11
    s_cmp_gt_u32 s8, 32
    s_cbranch_scc1 K2_FULL
K2_LAST:
    s_setprio 1
    s_add_u32 s10, s8, 7
    s_lshr_b32 s14, s10, 3
    ds_read_u16_d16_hi v80, v2 offset:2112
    ds_read_u16_d16_hi v81, v2 offset:2240
    ds_read_u16_d16_hi v82, v2 offset:2368
    ds_read_u16_d16_hi v83, v2 offset:2496
    ds_read_u16_d16_hi v84, v2 offset:3136
    ds_read_u16_d16_hi v85, v2 offset:3264
    ds_read_u16_d16_hi v86, v2 offset:3392
    ds_read_u16_d16_hi v87, v2 offset:3520
    ds_read_b64_tr_b16 v[32:33], v4 offset:0
    ds_read_b64_tr_b16 v[34:35], v4 offset:320
    ds_read_b64_tr_b16 v[36:37], v4 offset:640
    ds_read_b64_tr_b16 v[38:39], v4 offset:960
    s_cmp_ge_u32 s4, 8
    s_cbranch_scc1 K2_TL_12
    v_lshlrev_b32 v48, 4, v1
    s_xor_b32 s10, s7, s4
    s_and_b32 s10, s10, 1
    s_lshl_b32 s11, s4, 2
    s_or_b32 s10, s10, s11
    s_lshl_b32 s10, s10, 10
    s_add_u32 s10, s10, 327680
    buffer_load_dwordx4 v[12:15], v48, s[56:59], s10 offen
    s_mov_b32 s10, 393216
    buffer_load_dwordx4 v[16:19], v48, s[56:59], s10 offen
K2_TL_12:
    v_exp_f32 v48, v56
    v_exp_f32 v49, v57
    v_exp_f32 v50, v58
    v_exp_f32 v51, v59
    v_pk_add_f32 v[48:49], v[48:49], 1.0 op_sel_hi:[1,0]
    v_pk_add_f32 v[50:51], v[50:51], 1.0 op_sel_hi:[1,0]
    v_rcp_f32 v48, v48
    v_rcp_f32 v49, v49
    v_rcp_f32 v50, v50
    v_rcp_f32 v51, v51
    v_pk_mul_f32 v[56:57], v[56:57], v[48:49]
    v_pk_mul_f32 v[58:59], v[58:59], v[50:51]
    v_cvt_pk_bf16_f32 v40, v56, v57
    v_cvt_pk_bf16_f32 v41, v58, v59
    s_cmp_lt_u32 s14, 2
    s_cbranch_scc1 K2_S_13
    v_exp_f32 v48, v60
    v_exp_f32 v49, v61
    v_exp_f32 v50, v62
    v_exp_f32 v51, v63
    v_pk_add_f32 v[48:49], v[48:49], 1.0 op_sel_hi:[1,0]
    v_pk_add_f32 v[50:51], v[50:51], 1.0 op_sel_hi:[1,0]
    v_rcp_f32 v48, v48
    v_rcp_f32 v49, v49
    v_rcp_f32 v50, v50
    v_rcp_f32 v51, v51
    v_pk_mul_f32 v[60:61], v[60:61], v[48:49]
    v_pk_mul_f32 v[62:63], v[62:63], v[50:51]
    v_cvt_pk_bf16_f32 v42, v60, v61
    v_cvt_pk_bf16_f32 v43, v62, v63
K2_S_13:
    s_waitcnt lgkmcnt(0)
    v_mfma_f32_32x32x16_bf16 v[72:87], v[28:31], v[24:27], v[72:87]
    s_nop 1
    v_mfma_f32_32x32x16_bf16 v[88:103], v[40:43], v[32:35], v[88:103]
    s_cmp_lt_u32 s14, 3
    s_cbranch_scc1 K2_S_14
    v_exp_f32 v48, v64
    v_exp_f32 v49, v65
    v_exp_f32 v50, v66
    v_exp_f32 v51, v67
    v_pk_add_f32 v[48:49], v[48:49], 1.0 op_sel_hi:[1,0]
    v_pk_add_f32 v[50:51], v[50:51], 1.0 op_sel_hi:[1,0]
    v_rcp_f32 v48, v48
    v_rcp_f32 v49, v49
    v_rcp_f32 v50, v50
    v_rcp_f32 v51, v51
    v_pk_mul_f32 v[64:65], v[64:65], v[48:49]
    v_pk_mul_f32 v[66:67], v[66:67], v[50:51]
    v_cvt_pk_bf16_f32 v44, v64, v65
    v_cvt_pk_bf16_f32 v45, v66, v67
K2_S_14:
    s_cmp_ge_u32 s4, 8
    s_cbranch_scc1 K2_W2_15
    v_lshlrev_b32 v48, 4, v1
    s_lshl_b32 s10, s4, 12
    s_add_u32 s10, s10, 32768
    buffer_load_dwordx4 v[20:23], v48, s[56:59], s10 offen offset:0
    buffer_load_dwordx4 v[24:27], v48, s[56:59], s10 offen offset:1024
    buffer_load_dwordx4 v[28:31], v48, s[56:59], s10 offen offset:2048
    buffer_load_dwordx4 v[52:55], v48, s[56:59], s10 offen offset:3072
K2_W2_15:
    s_cmp_lt_u32 s14, 3
    s_cbranch_scc1 K2_S_16
    s_cmp_lt_u32 s14, 4
    s_cbranch_scc1 K2_S_17
    v_exp_f32 v48, v68
    v_exp_f32 v49, v69
    v_exp_f32 v50, v70
    v_exp_f32 v51, v71
    v_pk_add_f32 v[48:49], v[48:49], 1.0 op_sel_hi:[1,0]
    v_pk_add_f32 v[50:51], v[50:51], 1.0 op_sel_hi:[1,0]
    v_rcp_f32 v48, v48
    v_rcp_f32 v49, v49
    v_rcp_f32 v50, v50
    v_rcp_f32 v51, v51
    v_pk_mul_f32 v[68:69], v[68:69], v[48:49]
    v_pk_mul_f32 v[70:71], v[70:71], v[50:51]
    v_cvt_pk_bf16_f32 v46, v68, v69
    v_cvt_pk_bf16_f32 v47, v70, v71
K2_S_17:
    s_nop 1
    v_mfma_f32_32x32x16_bf16 v[88:103], v[44:47], v[36:39], v[88:103]
K2_S_16:
    s_cmp_ge_u32 s4, 8
    s_cbranch_scc1 K2_W2_18
    v_lshlrev_b32 v48, 4, v1
    s_lshl_b32 s10, s4, 12
    s_add_u32 s10, s10, 65536
    buffer_load_dwordx4 v[56:59], v48, s[56:59], s10 offen offset:0
    buffer_load_dwordx4 v[60:63], v48, s[56:59], s10 offen offset:1024
    buffer_load_dwordx4 v[64:67], v48, s[56:59], s10 offen offset:2048
    buffer_load_dwordx4 v[68:71], v48, s[56:59], s10 offen offset:3072
K2_W2_18:
    s_setprio 0
    v_exp_f32 v48, v72
    v_exp_f32 v49, v73
    v_exp_f32 v50, v74
    v_exp_f32 v51, v75
    v_pk_add_f32 v[48:49], v[48:49], 1.0 op_sel_hi:[1,0]
    v_pk_add_f32 v[50:51], v[50:51], 1.0 op_sel_hi:[1,0]
    v_rcp_f32 v48, v48
    v_rcp_f32 v49, v49
    v_rcp_f32 v50, v50
    v_rcp_f32 v51, v51
    v_pk_mul_f32 v[72:73], v[72:73], v[48:49]
    v_pk_mul_f32 v[74:75], v[74:75], v[50:51]
    v_cvt_pk_bf16_f32 v40, v72, v73
    v_cvt_pk_bf16_f32 v41, v74, v75
    s_cmp_lt_u32 s14, 2
    s_cbranch_scc1 K2_S_19
    v_exp_f32 v48, v76
    v_exp_f32 v49, v77
    v_exp_f32 v50, v78
    v_exp_f32 v51, v79
    v_pk_add_f32 v[48:49], v[48:49], 1.0 op_sel_hi:[1,0]
    v_pk_add_f32 v[50:51], v[50:51], 1.0 op_sel_hi:[1,0]
    v_rcp_f32 v48, v48
    v_rcp_f32 v49, v49
    v_rcp_f32 v50, v50
    v_rcp_f32 v51, v51
    v_pk_mul_f32 v[76:77], v[76:77], v[48:49]
    v_pk_mul_f32 v[78:79], v[78:79], v[50:51]
    v_cvt_pk_bf16_f32 v42, v76, v77
    v_cvt_pk_bf16_f32 v43, v78, v79
K2_S_19:
    s_nop 1
    v_mfma_f32_32x32x16_bf16 v[104:119], v[40:43], v[32:35], v[104:119]
    s_cmp_lt_u32 s14, 3
    s_cbranch_scc1 K2_S_20
    v_exp_f32 v48, v80
    v_exp_f32 v49, v81
    v_exp_f32 v50, v82
    v_exp_f32 v51, v83
    v_pk_add_f32 v[48:49], v[48:49], 1.0 op_sel_hi:[1,0]
    v_pk_add_f32 v[50:51], v[50:51], 1.0 op_sel_hi:[1,0]
    v_rcp_f32 v48, v48
    v_rcp_f32 v49, v49
    v_rcp_f32 v50, v50
    v_rcp_f32 v51, v51
    v_pk_mul_f32 v[80:81], v[80:81], v[48:49]
    v_pk_mul_f32 v[82:83], v[82:83], v[50:51]
    v_cvt_pk_bf16_f32 v44, v80, v81
    v_cvt_pk_bf16_f32 v45, v82, v83
    s_cmp_lt_u32 s14, 4
    s_cbranch_scc1 K2_S_21
    v_exp_f32 v48, v84
    v_exp_f32 v49, v85
    v_exp_f32 v50, v86
    v_exp_f32 v51, v87
    v_pk_add_f32 v[48:49], v[48:49], 1.0 op_sel_hi:[1,0]
    v_pk_add_f32 v[50:51], v[50:51], 1.0 op_sel_hi:[1,0]
    v_rcp_f32 v48, v48
    v_rcp_f32 v49, v49
    v_rcp_f32 v50, v50
    v_rcp_f32 v51, v51
    v_pk_mul_f32 v[84:85], v[84:85], v[48:49]
    v_pk_mul_f32 v[86:87], v[86:87], v[50:51]
    v_cvt_pk_bf16_f32 v46, v84, v85
    v_cvt_pk_bf16_f32 v47, v86, v87
K2_S_21:
    s_nop 1
    v_mfma_f32_32x32x16_bf16 v[104:119], v[44:47], v[36:39], v[104:119]
K2_S_20:
    s_branch K2_LOOP_END
K2_EMPTY:
    s_waitcnt vmcnt(0) lgkmcnt(0)
    s_cmp_ge_u32 s4, 8
    s_cbranch_scc1 K2_TL_22
    v_lshlrev_b32 v48, 4, v1
    s_xor_b32 s10, s7, s4
    s_and_b32 s10, s10, 1
    s_lshl_b32 s11, s4, 2
    s_or_b32 s10, s10, s11
    s_lshl_b32 s10, s10, 10
    s_add_u32 s10, s10, 327680
    buffer_load_dwordx4 v[12:15], v48, s[56:59], s10 offen
    s_mov_b32 s10, 393216
    buffer_load_dwordx4 v[16:19], v48, s[56:59], s10 offen
K2_TL_22:
    s_cmp_ge_u32 s4, 8
    s_cbranch_scc1 K2_W2_23
    v_lshlrev_b32 v48, 4, v1
    s_lshl_b32 s10, s4, 12
    s_add_u32 s10, s10, 32768
    buffer_load_dwordx4 v[20:23], v48, s[56:59], s10 offen offset:0
    buffer_load_dwordx4 v[24:27], v48, s[56:59], s10 offen offset:1024
    buffer_load_dwordx4 v[28:31], v48, s[56:59], s10 offen offset:2048
    buffer_load_dwordx4 v[52:55], v48, s[56:59], s10 offen offset:3072
K2_W2_23:
    s_cmp_ge_u32 s4, 8
    s_cbranch_scc1 K2_W2_24
    v_lshlrev_b32 v48, 4, v1
    s_lshl_b32 s10, s4, 12
    s_add_u32 s10, s10, 65536
    buffer_load_dwordx4 v[56:59], v48, s[56:59], s10 offen offset:0
    buffer_load_dwordx4 v[60:63], v48, s[56:59], s10 offen offset:1024
    buffer_load_dwordx4 v[64:67], v48, s[56:59], s10 offen offset:2048
    buffer_load_dwordx4 v[68:71], v48, s[56:59], s10 offen offset:3072
K2_W2_24:
K2_LOOP_END:
    s_or_b32 s10, s90, s91
    s_or_b32 s10, s10, s93
    s_cmp_eq_u32 s10, 0
    s_cbranch_scc1 K2_EPI
    s_waitcnt vmcnt(0) lgkmcnt(0)
    s_barrier
    v_mov_b32 v16, 0
    v_mov_b32 v17, 0
    v_mov_b32 v18, 0
    v_mov_b32 v19, 0
    v_lshlrev_b32 v13, 4, v0
    ds_write_b128 v13, v[16:19] offset:0
    ds_write_b128 v13, v[16:19] offset:16384
    ds_write_b128 v13, v[16:19] offset:32768
    s_cmp_ge_u32 s4, 12
    s_cbranch_scc1 K2_Z_25
    ds_write_b128 v13, v[16:19] offset:49152
K2_Z_25:
    s_cmp_lg_u32 s4, 15
    s_cbranch_scc1 K2_Z_26
    v_lshlrev_b32 v13, 4, v1
    s_mov_b32 exec_hi, 0xffff
    ds_write_b128 v13, v[16:19] offset:61440
    s_mov_b64 exec, -1
K2_Z_26:
    v_and_b32 v13, 31, v1
    v_lshrrev_b32 v14, 5, v1
    s_lshl_b32 s10, s7, 11
    s_add_u32 s10, s10, 40960
    v_lshlrev_b32 v15, 4, v13
    v_add_u32 v3, s10, v15
    s_mul_i32 s10, s7, 5120
    v_bfe_u32 v15, v1, 2, 2
    v_lshl_add_u32 v15, v14, 2, v15
    v_mul_u32_u24 v15, 40, v15
    v_bfe_u32 v16, v1, 4, 1
    v_lshl_add_u32 v15, v16, 5, v15
    v_and_b32 v16, 3, v1
    v_lshl_add_u32 v15, v16, 3, v15
    v_add_u32 v4, s10, v15
    s_lshl_b32 s10, s7, 9
    s_add_u32 s10, s10, 57344
    v_lshrrev_b32 v15, 3, v1
    v_lshlrev_b32 v15, 2, v15
    v_add_u32 v5, s10, v15
    s_mov_b32 s76, 0
    s_cmp_lg_u32 s93, 0
    s_cbranch_scc1 K2_NOREFILL
    s_ff1_i32_b64 s94, s[90:91]
    s_add_u32 s44, s36, 10485760
    s_addc_u32 s45, s37, 0
    s_mov_b32 s46, 2560000
    s_mov_b32 s47, 0x20000
    s_add_u32 s72, s36, 2752512
    s_addc_u32 s73, s37, 0
    s_mov_b32 s74, 256
    s_mov_b32 s75, 0x20000
    s_lshl_b32 s10, s94, 2
    v_mov_b32 v16, s10
    buffer_load_dword v17, v16, s[72:75], 0 offen
    s_mul_i32 s11, s94, 40000
    v_add_u32 v16, s92, v0
    v_lshlrev_b32 v18, 4, v16
    buffer_load_dwordx4 v[60:63], v18, s[44:47], s11 offen
    s_waitcnt vmcnt(0)
    v_cmp_lt_u32 vcc, v16, v17
    v_cmp_eq_u32 s[80:81], s2, v62
    s_and_b64 vcc, vcc, s[80:81]
    s_nop 1
    v_cndmask_b32 v8, -1, v60, vcc
    v_mov_b32 v9, v61
    v_cndmask_b32 v7, 0, 1, vcc
    v_mov_b32 v10, -1
    v_readfirstlane_b32 s10, v17
    s_add_u32 s92, s92, 1024
    s_cmp_lt_u32 s92, s10
    s_cbranch_scc1 K2_NOREFILL
    s_bitset0_b64 s[90:91], s94
    s_mov_b32 s92, 0
K2_NOREFILL:
    v_and_b32 v13, 2, v7
    v_cmp_ne_u32 s[84:85], 0, v13
    s_waitcnt lgkmcnt(0)
    s_barrier
    s_branch K2_ROUND
K2_EPI:
    s_mov_b32 s82, 0x000fffff
    s_mov_b32 s83, 0x000fffff
    s_lshr_b32 s10, s4, 2
    s_lshl_b32 s11, s10, 3
    s_lshr_b32 s12, 0x48642231, s11
    s_and_b32 s12, s12, 0xff
    s_mov_b32 s13, 0
    s_waitcnt vmcnt(8)
    v_xor_b32 v72, 16, v12
    v_xor_b32 v73, 64, v12
    v_xor_b32 v74, 80, v12
    v_lshlrev_b32 v10, 2, v1
    v_mov_b32 v11, 1
    v_cvt_pk_bf16_f32 v88, v88, v89
    v_cvt_pk_bf16_f32 v89, v90, v91
    v_cvt_pk_bf16_f32 v90, v92, v93
    v_cvt_pk_bf16_f32 v91, v94, v95
    v_cvt_pk_bf16_f32 v92, v96, v97
    v_cvt_pk_bf16_f32 v93, v98, v99
    v_cvt_pk_bf16_f32 v94, v100, v101
    v_cvt_pk_bf16_f32 v95, v102, v103
    v_cvt_pk_bf16_f32 v96, v104, v105
    v_cvt_pk_bf16_f32 v97, v106, v107
    v_cvt_pk_bf16_f32 v98, v108, v109
    v_cvt_pk_bf16_f32 v99, v110, v111
    v_cvt_pk_bf16_f32 v100, v112, v113
    v_cvt_pk_bf16_f32 v101, v114, v115
    v_cvt_pk_bf16_f32 v102, v116, v117
    v_cvt_pk_bf16_f32 v103, v118, v119
    s_mov_b64 exec, s[82:83]
    ds_write_b128 v12, v[88:91]
    ds_write_b128 v72, v[92:95]
    ds_write_b128 v73, v[96:99]
    ds_write_b128 v74, v[100:103]
    s_mov_b64 exec, s[12:13]
    ds_add_u32 v10, v11 offset:61520
    s_mov_b64 exec, -1
    s_mov_b32 s86, 3207688728
    s_mov_b32 s87, 3207688728
    s_cmp_lt_u32 s4, 8
    s_cbranch_scc1 K2_EL
    ds_read_u16_d16_hi v127, v14
    v_and_b32 v2, 48, v1
    ds_read_b128 v[104:107], v2 offset:62208
    ds_read_b128 v[108:111], v2 offset:62272
    ds_read_b128 v[112:115], v2 offset:62336
    ds_read_b128 v[116:119], v2 offset:62400
    v_xor_b32 v2, 64, v13
    s_sub_u32 s11, s4, 8
    s_lshl_b32 s11, s11, 1
    s_andn2_b32 s11, s11, 3
    v_mov_b32 v103, s11
    s_mul_i32 s95, s2, 240
    s_add_u32 s95, s95, 2560000
    s_mov_b32 s96, 0xffff
    s_bitcmp0_b32 s4, 0
    s_cselect_b32 s96, s96, 0x3fff
    s_mov_b32 s97, 0
    s_mov_b32 s100, 0x40000
K2_SPIN_27:
    ds_read_b32 v102, v103 offset:61520
    s_sub_u32 s100, s100, 1
    s_cselect_b32 s101, 0, 4
    s_waitcnt lgkmcnt(0)
    v_readfirstlane_b32 s11, v102
    s_cmp_lt_u32 s11, s101
    s_cbranch_scc1 K2_SPIN_27
    ds_read_b128 v[72:75], v13
    ds_read_b128 v[76:79], v2
    ds_read_b128 v[80:83], v13 offset:8192
    ds_read_b128 v[84:87], v2 offset:8192
    s_waitcnt lgkmcnt(3)
    v_mfma_f32_16x16x32_bf16 v[48:51], v[104:107], v[72:75], 0
    s_waitcnt lgkmcnt(2)
    v_mfma_f32_16x16x32_bf16 v[48:51], v[108:111], v[76:79], v[48:51]
    s_waitcnt lgkmcnt(1)
    v_mfma_f32_16x16x32_bf16 v[48:51], v[112:115], v[80:83], v[48:51]
    s_waitcnt lgkmcnt(0)
    v_mfma_f32_16x16x32_bf16 v[48:51], v[116:119], v[84:87], v[48:51]
    s_nop 7
    s_mov_b64 exec, s[96:97]
    v_fma_f32 v48, s86, v48, v127
    v_cvt_pk_bf16_f32 v48, v48, v48
    buffer_store_short v48, v15, s[68:71], s95 offen
    s_branch K2_FIN
K2_EL:
    s_mov_b32 s88, 3216550459
    s_mov_b32 s89, 3216550459
    ds_read_b128 v[72:75], v16 offset:9856
    ds_read_b128 v[76:79], v17 offset:9856
    ds_read_b128 v[80:83], v18 offset:9856
    ds_read_b128 v[84:87], v19 offset:9856
    ds_read_b128 v[32:35], v16 offset:13952
    ds_read_b128 v[36:39], v17 offset:13952
    ds_read_b128 v[40:43], v18 offset:13952
    ds_read_b128 v[44:47], v19 offset:13952
    ds_read_b128 v[104:107], v16 offset:18048
    ds_read_b128 v[108:111], v17 offset:18048
    ds_read_b128 v[112:115], v18 offset:18048
    ds_read_b128 v[116:119], v19 offset:18048
    s_lshr_b32 s11, s4, 1
    s_lshl_b32 s11, s11, 6
    s_and_b32 s12, s4, 1
    s_lshl_b32 s12, s12, 3
    s_or_b32 s11, s11, s12
    s_mul_i32 s98, s2, 10240
    s_add_u32 s98, s98, s11
    s_add_u32 s99, s98, 2048
    s_add_u32 s94, s98, 6144
    s_mov_b32 s80, 0xff00ff00
    s_mov_b32 s81, 0xff00ff00
    v_mov_b32 v103, 0
    s_waitcnt vmcnt(4)
    s_waitcnt lgkmcnt(11)
    v_mfma_f32_16x16x32_bf16 v[88:91], v[20:23], v[72:75], 0
    s_waitcnt lgkmcnt(7)
    v_mfma_f32_16x16x32_bf16 v[92:95], v[20:23], v[32:35], 0
    s_waitcnt lgkmcnt(3)
    v_mfma_f32_16x16x32_bf16 v[96:99], v[20:23], v[104:107], 0
    s_waitcnt lgkmcnt(10)
    v_mfma_f32_16x16x32_bf16 v[88:91], v[24:27], v[76:79], v[88:91]
    s_waitcnt lgkmcnt(6)
    v_mfma_f32_16x16x32_bf16 v[92:95], v[24:27], v[36:39], v[92:95]
    s_waitcnt lgkmcnt(2)
    v_mfma_f32_16x16x32_bf16 v[96:99], v[24:27], v[108:111], v[96:99]
    s_waitcnt lgkmcnt(9)
    v_mfma_f32_16x16x32_bf16 v[88:91], v[28:31], v[80:83], v[88:91]
    s_waitcnt lgkmcnt(5)
    v_mfma_f32_16x16x32_bf16 v[92:95], v[28:31], v[40:43], v[92:95]
    s_waitcnt lgkmcnt(1)
    v_mfma_f32_16x16x32_bf16 v[96:99], v[28:31], v[112:115], v[96:99]
    s_waitcnt lgkmcnt(8)
    v_mfma_f32_16x16x32_bf16 v[88:91], v[52:55], v[84:87], v[88:91]
    s_waitcnt lgkmcnt(4)
    v_mfma_f32_16x16x32_bf16 v[92:95], v[52:55], v[44:47], v[92:95]
    s_waitcnt lgkmcnt(0)
    v_mfma_f32_16x16x32_bf16 v[96:99], v[52:55], v[116:119], v[96:99]
    ds_read_b64 v[2:3], v13 offset:9856
    ds_read_b64 v[4:5], v13 offset:13952
    ds_read_b64 v[6:7], v13 offset:18048
    s_nop 3
    s_waitcnt lgkmcnt(0)
    v_lshlrev_b32 v32, 16, v2
    v_and_b32 v33, 0xffff0000, v2
    v_lshlrev_b32 v34, 16, v3
    v_and_b32 v35, 0xffff0000, v3
    v_lshlrev_b32 v36, 16, v4
    v_and_b32 v37, 0xffff0000, v4
    v_lshlrev_b32 v38, 16, v5
    v_and_b32 v39, 0xffff0000, v5
    v_lshlrev_b32 v40, 16, v6
    v_and_b32 v41, 0xffff0000, v6
    v_lshlrev_b32 v42, 16, v7
    v_and_b32 v43, 0xffff0000, v7
    v_pk_mul_f32 v[88:89], v[88:89], s[88:89]
    v_pk_mul_f32 v[90:91], v[90:91], s[88:89]
    v_pk_mul_f32 v[92:93], v[92:93], s[88:89]
    v_pk_mul_f32 v[94:95], v[94:95], s[88:89]
    v_pk_mul_f32 v[96:97], v[96:97], s[88:89]
    v_pk_mul_f32 v[98:99], v[98:99], s[88:89]
    s_waitcnt vmcnt(0)
    s_mov_b32 s100, 0x40000
K2_AG_28:
    ds_read_b32 v102, v103 offset:61536
    ds_read_b128 v[72:75], v16 offset:20096
    ds_read_b128 v[76:79], v17 offset:20096
    ds_read_b128 v[80:83], v18 offset:20096
    ds_read_b128 v[84:87], v19 offset:20096
    s_waitcnt lgkmcnt(4)
    v_readfirstlane_b32 s11, v102
    s_cmp_ge_u32 s11, 4
    s_cbranch_scc1 K2_GO_29
K2_SPIN_30:
    ds_read_b32 v102, v103 offset:61536
    s_sub_u32 s100, s100, 1
    s_cbranch_scc1 K2_GO_29
    s_waitcnt lgkmcnt(0)
    v_readfirstlane_b32 s11, v102
    s_cmp_lt_u32 s11, 4
    s_cbranch_scc1 K2_SPIN_30
    s_branch K2_AG_28
K2_GO_29:
    s_waitcnt lgkmcnt(3)
    v_mfma_f32_16x16x32_bf16 v[88:91], v[56:59], v[72:75], v[88:91]
    s_waitcnt lgkmcnt(2)
    v_mfma_f32_16x16x32_bf16 v[88:91], v[60:63], v[76:79], v[88:91]
    s_waitcnt lgkmcnt(1)
    v_mfma_f32_16x16x32_bf16 v[88:91], v[64:67], v[80:83], v[88:91]
    s_waitcnt lgkmcnt(0)
    v_mfma_f32_16x16x32_bf16 v[88:91], v[68:71], v[84:87], v[88:91]
    s_nop 7
    v_exp_f32 v120, v88
    v_exp_f32 v121, v89
    v_exp_f32 v122, v90
    v_exp_f32 v123, v91
    v_pk_add_f32 v[120:121], v[120:121], 1.0 op_sel_hi:[1,0]
    v_pk_add_f32 v[122:123], v[122:123], 1.0 op_sel_hi:[1,0]
    v_rcp_f32 v120, v120
    v_rcp_f32 v121, v121
    v_rcp_f32 v122, v122
    v_rcp_f32 v123, v123
    v_pk_mul_f32 v[88:89], v[88:89], v[120:121]
    v_pk_mul_f32 v[90:91], v[90:91], v[122:123]
    v_pk_fma_f32 v[32:33], v[88:89], s[86:87], v[32:33]
    v_pk_fma_f32 v[34:35], v[90:91], s[86:87], v[34:35]
    v_cvt_pk_bf16_f32 v124, v32, v33
    v_cvt_pk_bf16_f32 v125, v34, v35
    s_mov_b64 exec, s[80:81]
    buffer_store_dwordx2 v[124:125], v14, s[68:71], s98 offen
    s_mov_b64 exec, -1
    s_mov_b32 s100, 0x40000
K2_AG_31:
    ds_read_b32 v102, v103 offset:61540
    ds_read_b128 v[104:107], v16 offset:24192
    ds_read_b128 v[108:111], v17 offset:24192
    ds_read_b128 v[112:115], v18 offset:24192
    ds_read_b128 v[116:119], v19 offset:24192
    s_waitcnt lgkmcnt(4)
    v_readfirstlane_b32 s11, v102
    s_cmp_ge_u32 s11, 12
    s_cbranch_scc1 K2_GO_32
K2_SPIN_33:
    ds_read_b32 v102, v103 offset:61540
    s_sub_u32 s100, s100, 1
    s_cbranch_scc1 K2_GO_32
    s_waitcnt lgkmcnt(0)
    v_readfirstlane_b32 s11, v102
    s_cmp_lt_u32 s11, 12
    s_cbranch_scc1 K2_SPIN_33
    s_branch K2_AG_31
K2_GO_32:
    s_waitcnt lgkmcnt(3)
    v_mfma_f32_16x16x32_bf16 v[92:95], v[56:59], v[104:107], v[92:95]
    s_waitcnt lgkmcnt(2)
    v_mfma_f32_16x16x32_bf16 v[92:95], v[60:63], v[108:111], v[92:95]
    s_waitcnt lgkmcnt(1)
    v_mfma_f32_16x16x32_bf16 v[92:95], v[64:67], v[112:115], v[92:95]
    s_waitcnt lgkmcnt(0)
    v_mfma_f32_16x16x32_bf16 v[92:95], v[68:71], v[116:119], v[92:95]
    s_nop 7
    v_exp_f32 v120, v92
    v_exp_f32 v121, v93
    v_exp_f32 v122, v94
    v_exp_f32 v123, v95
    v_pk_add_f32 v[120:121], v[120:121], 1.0 op_sel_hi:[1,0]
    v_pk_add_f32 v[122:123], v[122:123], 1.0 op_sel_hi:[1,0]
    v_rcp_f32 v120, v120
    v_rcp_f32 v121, v121
    v_rcp_f32 v122, v122
    v_rcp_f32 v123, v123
    v_pk_mul_f32 v[92:93], v[92:93], v[120:121]
    v_pk_mul_f32 v[94:95], v[94:95], v[122:123]
    v_pk_fma_f32 v[36:37], v[92:93], s[86:87], v[36:37]
    v_pk_fma_f32 v[38:39], v[94:95], s[86:87], v[38:39]
    v_cvt_pk_bf16_f32 v10, v36, v37
    v_cvt_pk_bf16_f32 v11, v38, v39
    buffer_store_dwordx2 v[10:11], v15, s[68:71], s99 offen
    s_mov_b32 s100, 0x40000
K2_AG_34:
    ds_read_b32 v102, v103 offset:61544
    ds_read_b128 v[72:75], v16 offset:28288
    ds_read_b128 v[76:79], v17 offset:28288
    ds_read_b128 v[80:83], v18 offset:28288
    ds_read_b128 v[84:87], v19 offset:28288
    s_waitcnt lgkmcnt(4)
    v_readfirstlane_b32 s11, v102
    s_cmp_ge_u32 s11, 8
    s_cbranch_scc1 K2_GO_35
K2_SPIN_36:
    ds_read_b32 v102, v103 offset:61544
    s_sub_u32 s100, s100, 1
    s_cbranch_scc1 K2_GO_35
    s_waitcnt lgkmcnt(0)
    v_readfirstlane_b32 s11, v102
    s_cmp_lt_u32 s11, 8
    s_cbranch_scc1 K2_SPIN_36
    s_branch K2_AG_34
K2_GO_35:
    s_waitcnt lgkmcnt(3)
    v_mfma_f32_16x16x32_bf16 v[96:99], v[56:59], v[72:75], v[96:99]
    s_waitcnt lgkmcnt(2)
    v_mfma_f32_16x16x32_bf16 v[96:99], v[60:63], v[76:79], v[96:99]
    s_waitcnt lgkmcnt(1)
    v_mfma_f32_16x16x32_bf16 v[96:99], v[64:67], v[80:83], v[96:99]
    s_waitcnt lgkmcnt(0)
    v_mfma_f32_16x16x32_bf16 v[96:99], v[68:71], v[84:87], v[96:99]
    s_nop 7
    v_exp_f32 v120, v96
    v_exp_f32 v121, v97
    v_exp_f32 v122, v98
    v_exp_f32 v123, v99
    v_pk_add_f32 v[120:121], v[120:121], 1.0 op_sel_hi:[1,0]
    v_pk_add_f32 v[122:123], v[122:123], 1.0 op_sel_hi:[1,0]
    v_rcp_f32 v120, v120
    v_rcp_f32 v121, v121
    v_rcp_f32 v122, v122
    v_rcp_f32 v123, v123
    v_pk_mul_f32 v[96:97], v[96:97], v[120:121]
    v_pk_mul_f32 v[98:99], v[98:99], v[122:123]
    v_pk_fma_f32 v[40:41], v[96:97], s[86:87], v[40:41]
    v_pk_fma_f32 v[42:43], v[98:99], s[86:87], v[42:43]
    v_cvt_pk_bf16_f32 v124, v40, v41
    v_cvt_pk_bf16_f32 v125, v42, v43
    buffer_store_dwordx2 v[124:125], v15, s[68:71], s94 offen
K2_FIN:
    s_mov_b64 exec, -1
K2_END:
    s_endpgm
.section .rodata,"a"
.p2align 6
.amdhsa_kernel egnn_edge_kernel
  .amdhsa_next_free_vgpr 128
  .amdhsa_next_free_sgpr 102
  .amdhsa_accum_offset 128
  .amdhsa_group_segment_fixed_size 0
  .amdhsa_kernarg_size 88
  .amdhsa_user_sgpr_count 2
  .amdhsa_user_sgpr_kernarg_segment_ptr 1
  .amdhsa_system_sgpr_workgroup_id_x 1
.end_amdhsa_kernel
.text
```
